```python
import torch

def _softmax(x, axis=-1):
    return torch.softmax(x, dim=axis)
def _gelu(x):
    return torch.nn.functional.gelu(x, approximate="tanh")
def _silu(x):
    return torch.nn.functional.silu(x)
def _sigmoid(x):
    return torch.sigmoid(x)
def _layernorm(x, axis=-1, eps=1e-5):
    m = x.mean(dim=axis, keepdim=True)
    v = x.var(dim=axis, keepdim=True, unbiased=False)
    return (x - m) / torch.sqrt(v + eps)
def _scatter_add(tgt, idx, src, axis=0):
    return tgt.clone().index_add_(axis, idx, src)
def _segment_sum(src, seg, n):
    out = torch.zeros((n,) + src.shape[1:], dtype=src.dtype)
    return out.index_add_(0, seg, src)
def _pad(x, pw):
    flat = tuple(v for pair in reversed(pw) for v in pair)
    return torch.nn.functional.pad(x, flat)

kernel_name = 'recurrent_scan__spectral_gfnet__glu_gated_glu__prompt'

def setup_inputs():

    _w = (lambda a: (lambda t: t.to(torch.bfloat16) if t.is_floating_point() else t)(torch.as_tensor(a)))
    def _A_setup():
        B, S, D = 1, 2048, 512
        Df = D // 2 + 1
        return {
            "x": _w((lambda *s: torch.randn(*s, dtype=torch.bfloat16) * 0.05)(B, S, D)),
            "w_r": _w((lambda *s: torch.randn(*s, dtype=torch.bfloat16) * 0.05)(S, Df) * 0.02),
            "w_i": _w((lambda *s: torch.randn(*s, dtype=torch.bfloat16) * 0.05)(S, Df) * 0.02),
        }
    _A_in = _A_setup()

    def _B_setup():
        B, S, D, F = 1, 2048, 512, 1792
        return {
            "x": _w((lambda *s: torch.randn(*s, dtype=torch.bfloat16) * 0.05)(B, S, D)),
            "w_gate": _w((lambda *s: torch.randn(*s, dtype=torch.bfloat16) * 1.6)(D, F)),
            "w_up": _w((lambda *s: torch.randn(*s, dtype=torch.bfloat16) * 0.1)(D, F)),
            "w_down": _w((lambda *s: torch.randn(*s, dtype=torch.bfloat16) * 0.1)(F, D)),
        }
    _B_in = _B_setup()

    return {
        "A_x": _A_in["x"],
        "A_w_r": _A_in["w_r"],
        "A_w_i": _A_in["w_i"],
        "B_x": _B_in["x"],
        "B_w_gate": _B_in["w_gate"],
        "B_w_up": _B_in["w_up"],
        "B_w_down": _B_in["w_down"],
    }

def reference(A_x, A_w_r, A_w_i, B_x, B_w_gate, B_w_up, B_w_down):
    def _A_ref(x, w_r, w_i):
        B, S, D = x.shape
        X = (lambda x, axes=(-2,-1): torch.fft.rfft2(x.float(), dim=axes))(x, axes=(-2, -1))
        W = w_r + 1j * w_i
        X = X * W
        y = (lambda x, s, axes=(-2,-1): torch.fft.irfft2(x, s=s, dim=axes).to(torch.bfloat16))(X, (S, D), axes=(-2, -1))
        return y

    def _B_ref(x, w_gate, w_up, w_down):
        g = torch.einsum("bsd,df->bsf", x, w_gate)
        u = torch.einsum("bsd,df->bsf", x, w_up)
        h = _sigmoid(g) * u
        return torch.einsum("bsf,fd->bsd", h, w_down)

    x = A_x
    xn = _layernorm(x, axis=-1)
    s = _A_ref(xn, A_w_r, A_w_i)
    g = _silu(_B_ref(xn, B_w_gate, B_w_up, B_w_down))
    return x + s * g
```

```asm
; @launch grid=(256,1,1) block=(256,1,1) lds=163840
.amdgcn_target "amdgcn-amd-amdhsa--gfx950"
.text
.globl recurrent_scan__spectral_gfnet__glu_gated_glu__prompt_kernel
.p2align 8
.type recurrent_scan__spectral_gfnet__glu_gated_glu__prompt_kernel,@function
recurrent_scan__spectral_gfnet__glu_gated_glu__prompt_kernel:
    s_cmp_ge_u32 s2, 256
    s_cbranch_scc1 L_end
    s_load_dwordx2 s[4:5], s[0:1], 0
    s_load_dwordx2 s[32:33], s[0:1], 72
    s_load_dwordx2 s[8:9], s[0:1], 8
    s_load_dwordx2 s[12:13], s[0:1], 16
    s_load_dwordx2 s[16:17], s[0:1], 32
    s_load_dwordx2 s[20:21], s[0:1], 40
    s_load_dwordx2 s[24:25], s[0:1], 48
    s_load_dwordx2 s[28:29], s[0:1], 56
    s_getpc_b64 s[46:47]
L_pc:
    s_sub_u32 s46, s46, L_pc-recurrent_scan__spectral_gfnet__glu_gated_glu__prompt_kernel
    s_subb_u32 s47, s47, 0
    s_lshr_b32 s48, s2, 3
    s_mul_i32 s48, s48, 1024
    v_subrev_u32 v6, 192, v0
    v_cmp_gt_u32 vcc, 8, v6
    v_lshl_add_u32 v6, v6, 7, s48
    v_min_u32 v6, L_code_end-recurrent_scan__spectral_gfnet__glu_gated_glu__prompt_kernel-4, v6
    v_mov_b32 v7, 0
    v_lshl_add_u64 v[6:7], v[6:7], 0, s[46:47]
    s_and_saveexec_b64 s[48:49], vcc
    s_cbranch_execz L_nopf
    global_load_dword a255, v[6:7], off
L_nopf:
    s_mov_b64 exec, s[48:49]
    v_and_b32 v1, 63, v0
    v_lshrrev_b32 v2, 6, v0
    s_nop 0
    v_readfirstlane_b32 s36, v2
    v_lshlrev_b32 v2, 4, v1
    s_mov_b32 s6, 0x200000
    s_mov_b32 s7, 0x20000
    s_mov_b32 s34, 0x1121000
    s_mov_b32 s35, 0x20000
    s_mov_b32 s10, 0x101000
    s_mov_b32 s11, 0x20000
    s_mov_b32 s14, 0x101000
    s_mov_b32 s15, 0x20000
    s_mov_b32 s18, 0x1c0000
    s_mov_b32 s19, 0x20000
    s_mov_b32 s22, 0x1c0000
    s_mov_b32 s23, 0x20000
    s_mov_b32 s26, 0x1c0000
    s_mov_b32 s27, 0x20000
    s_mov_b32 s30, 0x200000
    s_mov_b32 s31, 0x20000
    s_lshr_b32 s38, s2, 5
    s_lshl_b32 s38, s38, 8
    s_and_b32 s39, s2, 31
    s_add_u32 s38, s38, s39
    s_lshl_b32 s38, s38, 10
    s_lshl_b32 s39, s36, 16
    s_add_u32 s39, s38, s39
    s_add_u32 s40, s39, 32768
    s_waitcnt lgkmcnt(0)
    buffer_load_dwordx4 v[8:11], v2, s[4:7], s39 offen
    buffer_load_dwordx4 v[12:15], v2, s[4:7], s40 offen
    s_mov_b32 s44, 0x1119000
    buffer_load_dword v119, off, s[32:35], s44 sc1
    s_and_b32 s41, s2, 63
    s_lshr_b32 s42, s2, 6
    s_lshl_b32 s42, s42, 9
    s_add_u32 s41, s41, s42
    s_mul_i32 s41, s41, 514
    s_add_u32 s41, s41, 2
    s_and_b32 s48, s41, 2
    s_and_b32 s41, s41, 0xfffffffc
    v_lshrrev_b32 v3, 5, v1
    v_and_b32 v4, 31, v1
    v_mov_b32 v29, 0x7ff00000
    v_cmp_gt_u32 vcc, 33, v1
    s_mul_i32 s42, s36, 65792
    s_add_u32 s41, s41, s42
    v_cndmask_b32 v5, v29, v2, vcc
    s_lshl_b32 s49, s36, 11
    s_add_u32 m0, s49, 124928
    s_add_u32 s42, s41, 32896
    buffer_load_dwordx4 v5, s[8:11], s41 offen nt lds
    s_add_u32 m0, s49, 125952
    s_nop 0
    buffer_load_dwordx4 v5, s[8:11], s42 offen nt lds
    s_add_u32 m0, s49, 133120
    s_add_u32 s42, s41, 32896
    buffer_load_dwordx4 v5, s[12:15], s41 offen nt lds
    s_add_u32 m0, s49, 134144
    s_nop 0
    buffer_load_dwordx4 v5, s[12:15], s42 offen nt lds
    v_add_u32 v6, 1, v4
    v_lshlrev_b32 v30, 31, v6
    v_lshrrev_b32 v31, 16, v30
    v_or_b32 v30, v30, v31
    v_cvt_f32_u32 v6, v6
    v_mul_f32 v7, 0x3d000000, v6
    v_cvt_f32_u32 v20, v3
    v_mul_f32 v21, 0x41000000, v20
    v_mul_f32 v16, v21, v7
    v_add_f32 v17, v16, v7
    v_cos_f32 v18, v16
    v_cos_f32 v19, v17
    v_sin_f32 v22, v16
    v_sin_f32 v23, v17
    v_add_f32 v16, v17, v7
    v_cvt_pk_bf16_f32 v64, v18, v19
    v_cvt_pk_bf16_f32 v72, -v22, -v23
    v_xor_b32 v68, v64, v30
    v_xor_b32 v76, v72, v30
    v_add_f32 v17, v16, v7
    v_cos_f32 v18, v16
    v_cos_f32 v19, v17
    v_sin_f32 v22, v16
    v_sin_f32 v23, v17
    v_add_f32 v16, v17, v7
    v_cvt_pk_bf16_f32 v65, v18, v19
    v_cvt_pk_bf16_f32 v73, -v22, -v23
    v_xor_b32 v69, v65, v30
    v_xor_b32 v77, v73, v30
    v_add_f32 v17, v16, v7
    v_cos_f32 v18, v16
    v_cos_f32 v19, v17
    v_sin_f32 v22, v16
    v_sin_f32 v23, v17
    v_add_f32 v16, v17, v7
    v_cvt_pk_bf16_f32 v66, v18, v19
    v_cvt_pk_bf16_f32 v74, -v22, -v23
    v_xor_b32 v70, v66, v30
    v_xor_b32 v78, v74, v30
    v_add_f32 v17, v16, v7
    v_cos_f32 v18, v16
    v_cos_f32 v19, v17
    v_sin_f32 v22, v16
    v_sin_f32 v23, v17
    v_cvt_pk_bf16_f32 v67, v18, v19
    v_cvt_pk_bf16_f32 v75, -v22, -v23
    v_xor_b32 v71, v67, v30
    v_xor_b32 v79, v75, v30
    v_mul_f32 v7, 0x3b000000, v6
    v_mul_f32 v22, 4.0, v20
    v_mul_f32 v16, v22, v7
    v_mul_f32 v17, 4.0, v7
    v_cos_f32 v80, v16
    v_sin_f32 v88, v16
    v_add_f32 v16, v16, v7
    v_cos_f32 v81, v16
    v_sin_f32 v89, v16
    v_add_f32 v16, v16, v7
    v_cos_f32 v82, v16
    v_sin_f32 v90, v16
    v_add_f32 v16, v16, v7
    v_cos_f32 v83, v16
    v_sin_f32 v91, v16
    v_add_f32 v16, v16, v7
    v_add_f32 v16, v16, v17
    v_cos_f32 v84, v16
    v_sin_f32 v92, v16
    v_add_f32 v16, v16, v7
    v_cos_f32 v85, v16
    v_sin_f32 v93, v16
    v_add_f32 v16, v16, v7
    v_cos_f32 v86, v16
    v_sin_f32 v94, v16
    v_add_f32 v16, v16, v7
    v_cos_f32 v87, v16
    v_sin_f32 v95, v16
    s_mul_i32 s42, s36, 2560
    s_add_u32 s42, s42, 98304
    v_add_u32 v27, s42, v2
    v_bfe_u32 v6, v1, 4, 1
    v_mul_u32_u24 v6, 1152, v6
    v_lshl_add_u32 v6, v3, 8, v6
    v_bfe_u32 v7, v1, 2, 2
    v_lshl_add_u32 v6, v7, 5, v6
    v_and_b32 v7, 3, v1
    v_lshl_add_u32 v6, v7, 3, v6
    v_add_u32 v24, s42, v6
    v_lshlrev_b32 v6, 6, v4
    v_lshl_add_u32 v6, v3, 13, v6
    s_lshl_b32 s43, s36, 2
    s_add_u32 s43, s43, 108544
    v_add_u32 v25, s43, v6
    v_bfe_u32 v6, v4, 1, 2
    v_lshl_add_u32 v25, v6, 4, v25
    v_add_u32 v28, 98304, v2
    v_mov_b32 v26, 0x3f803f80
    v_mov_b64 v[16:17], 0
    s_add_u32 s39, s39, 0x800000
    s_add_u32 s40, s40, 0x800000
    v_cmp_gt_u32 vcc, 7, v1
    v_lshlrev_b32 v31, 7, v1
    s_lshr_b32 s38, s2, 1
    s_mul_i32 s38, s38, 3584
    s_mul_i32 s43, s36, 896
    s_add_u32 s38, s38, s43
    v_cndmask_b32 v31, v29, v31, vcc
    s_waitcnt vmcnt(5)
    v_dot2c_f32_bf16 v16, v8, v26
    v_dot2c_f32_bf16 v17, v12, v26
    v_dot2c_f32_bf16 v16, v9, v26
    v_dot2c_f32_bf16 v17, v13, v26
    v_dot2c_f32_bf16 v16, v10, v26
    v_dot2c_f32_bf16 v17, v14, v26
    v_dot2c_f32_bf16 v16, v11, v26
    v_dot2c_f32_bf16 v17, v15, v26
    v_lshlrev_b32 v32, 16, v8
    v_and_b32 v33, 0xffff0000, v8
    v_lshlrev_b32 v34, 16, v9
    v_and_b32 v35, 0xffff0000, v9
    v_add_f32_dpp v16, v16, v16 row_shr:1 row_mask:0xf bank_mask:0xf bound_ctrl:1
    v_add_f32_dpp v17, v17, v17 row_shr:1 row_mask:0xf bank_mask:0xf bound_ctrl:1
    v_lshlrev_b32 v36, 16, v10
    v_add_f32_dpp v16, v16, v16 row_shr:2 row_mask:0xf bank_mask:0xf bound_ctrl:1
    v_add_f32_dpp v17, v17, v17 row_shr:2 row_mask:0xf bank_mask:0xf bound_ctrl:1
    v_and_b32 v37, 0xffff0000, v10
    v_add_f32_dpp v16, v16, v16 row_shr:4 row_mask:0xf bank_mask:0xf bound_ctrl:1
    v_add_f32_dpp v17, v17, v17 row_shr:4 row_mask:0xf bank_mask:0xf bound_ctrl:1
    v_lshlrev_b32 v38, 16, v11
    v_add_f32_dpp v16, v16, v16 row_shr:8 row_mask:0xf bank_mask:0xf bound_ctrl:1
    v_add_f32_dpp v17, v17, v17 row_shr:8 row_mask:0xf bank_mask:0xf bound_ctrl:1
    v_and_b32 v39, 0xffff0000, v11
    v_add_f32_dpp v16, v16, v16 row_bcast:15 row_mask:0xa bank_mask:0xf
    v_add_f32_dpp v17, v17, v17 row_bcast:15 row_mask:0xa bank_mask:0xf
    v_lshlrev_b32 v40, 16, v12
    v_add_f32_dpp v16, v16, v16 row_bcast:31 row_mask:0xc bank_mask:0xf
    v_add_f32_dpp v17, v17, v17 row_bcast:31 row_mask:0xc bank_mask:0xf
    v_and_b32 v41, 0xffff0000, v12
    v_lshlrev_b32 v42, 16, v13
    v_and_b32 v43, 0xffff0000, v13
    v_lshlrev_b32 v44, 16, v14
    v_and_b32 v45, 0xffff0000, v14
    v_lshlrev_b32 v46, 16, v15
    v_and_b32 v47, 0xffff0000, v15
    v_readlane_b32 s44, v16, 63
    v_readlane_b32 s45, v17, 63
    v_mov_b32 v18, 0xbb000000
    v_mul_f32 v16, s44, v18
    v_mul_f32 v17, s45, v18
    v_pk_add_f32 v[32:33], v[32:33], v[16:17] op_sel_hi:[1,0]
    v_pk_add_f32 v[40:41], v[40:41], v[16:17] op_sel:[0,1] op_sel_hi:[1,1]
    v_pk_add_f32 v[34:35], v[34:35], v[16:17] op_sel_hi:[1,0]
    v_pk_add_f32 v[42:43], v[42:43], v[16:17] op_sel:[0,1] op_sel_hi:[1,1]
    v_pk_add_f32 v[36:37], v[36:37], v[16:17] op_sel_hi:[1,0]
    v_pk_add_f32 v[44:45], v[44:45], v[16:17] op_sel:[0,1] op_sel_hi:[1,1]
    v_pk_add_f32 v[38:39], v[38:39], v[16:17] op_sel_hi:[1,0]
    v_pk_add_f32 v[46:47], v[46:47], v[16:17] op_sel:[0,1] op_sel_hi:[1,1]
    v_pk_mul_f32 v[18:19], v[32:33], v[32:33]
    v_pk_mul_f32 v[22:23], v[40:41], v[40:41]
    v_pk_fma_f32 v[18:19], v[34:35], v[34:35], v[18:19]
    v_pk_fma_f32 v[22:23], v[42:43], v[42:43], v[22:23]
    v_pk_fma_f32 v[18:19], v[36:37], v[36:37], v[18:19]
    v_pk_fma_f32 v[22:23], v[44:45], v[44:45], v[22:23]
    v_pk_fma_f32 v[18:19], v[38:39], v[38:39], v[18:19]
    v_pk_fma_f32 v[22:23], v[46:47], v[46:47], v[22:23]
    v_add_f32 v18, v18, v19
    v_add_f32 v19, v22, v23
    v_cvt_pk_bf16_f32 v20, v16, v17
    v_add_f32_dpp v18, v18, v18 row_shr:1 row_mask:0xf bank_mask:0xf bound_ctrl:1
    v_add_f32_dpp v19, v19, v19 row_shr:1 row_mask:0xf bank_mask:0xf bound_ctrl:1
    v_lshlrev_b32 v21, 16, v20
    v_add_f32_dpp v18, v18, v18 row_shr:2 row_mask:0xf bank_mask:0xf bound_ctrl:1
    v_add_f32_dpp v19, v19, v19 row_shr:2 row_mask:0xf bank_mask:0xf bound_ctrl:1
    v_and_b32 v20, 0xffff0000, v20
    v_add_f32_dpp v18, v18, v18 row_shr:4 row_mask:0xf bank_mask:0xf bound_ctrl:1
    v_add_f32_dpp v19, v19, v19 row_shr:4 row_mask:0xf bank_mask:0xf bound_ctrl:1
    v_sub_f32 v16, v21, v16
    v_add_f32_dpp v18, v18, v18 row_shr:8 row_mask:0xf bank_mask:0xf bound_ctrl:1
    v_add_f32_dpp v19, v19, v19 row_shr:8 row_mask:0xf bank_mask:0xf bound_ctrl:1
    v_sub_f32 v17, v20, v17
    v_add_f32_dpp v18, v18, v18 row_bcast:15 row_mask:0xa bank_mask:0xf
    v_add_f32_dpp v19, v19, v19 row_bcast:15 row_mask:0xa bank_mask:0xf
    v_mov_b32 v20, 0x3b000000
    v_add_f32_dpp v18, v18, v18 row_bcast:31 row_mask:0xc bank_mask:0xf
    v_add_f32_dpp v19, v19, v19 row_bcast:31 row_mask:0xc bank_mask:0xf
    v_readlane_b32 s44, v18, 63
    v_readlane_b32 s45, v19, 63
    s_nop 0
    v_mul_f32 v18, s44, v20
    v_mul_f32 v19, s45, v20
    v_cvt_pk_bf16_f32 v20, v18, v19
    v_lshlrev_b32 v18, 16, v20
    v_and_b32 v19, 0xffff0000, v20
    v_add_f32 v18, 0x3727c5ac, v18
    v_add_f32 v19, 0x3727c5ac, v19
    v_cvt_pk_bf16_f32 v20, v18, v19
    v_lshlrev_b32 v18, 16, v20
    v_and_b32 v19, 0xffff0000, v20
    v_sqrt_f32 v18, v18
    v_sqrt_f32 v19, v19
    s_nop 0
    v_cvt_pk_bf16_f32 v20, v18, v19
    v_lshlrev_b32 v18, 16, v20
    v_and_b32 v19, 0xffff0000, v20
    v_rcp_f32 v18, v18
    v_rcp_f32 v19, v19
    s_nop 0
    v_pk_mul_f32 v[16:17], v[16:17], v[18:19]
    v_pk_fma_f32 v[32:33], v[32:33], v[18:19], v[16:17] op_sel_hi:[1,0,0]
    v_pk_fma_f32 v[34:35], v[34:35], v[18:19], v[16:17] op_sel_hi:[1,0,0]
    v_pk_fma_f32 v[36:37], v[36:37], v[18:19], v[16:17] op_sel_hi:[1,0,0]
    v_pk_fma_f32 v[38:39], v[38:39], v[18:19], v[16:17] op_sel_hi:[1,0,0]
    v_cvt_pk_bf16_f32 v8, v32, v33
    v_cvt_pk_bf16_f32 v9, v34, v35
    v_cvt_pk_bf16_f32 v10, v36, v37
    v_cvt_pk_bf16_f32 v11, v38, v39
    ds_write_b128 v27, v[8:11]
    buffer_store_dwordx4 v[8:11], v2, s[32:35], s39 offen sc1
    v_pk_fma_f32 v[40:41], v[40:41], v[18:19], v[16:17] op_sel:[0,1,1] op_sel_hi:[1,1,1]
    v_pk_fma_f32 v[42:43], v[42:43], v[18:19], v[16:17] op_sel:[0,1,1] op_sel_hi:[1,1,1]
    v_pk_fma_f32 v[44:45], v[44:45], v[18:19], v[16:17] op_sel:[0,1,1] op_sel_hi:[1,1,1]
    v_pk_fma_f32 v[46:47], v[46:47], v[18:19], v[16:17] op_sel:[0,1,1] op_sel_hi:[1,1,1]
    v_cvt_pk_bf16_f32 v12, v40, v41
    v_cvt_pk_bf16_f32 v13, v42, v43
    v_cvt_pk_bf16_f32 v14, v44, v45
    v_cvt_pk_bf16_f32 v15, v46, v47
    ds_write_b128 v27, v[12:15] offset:1152
    buffer_store_dwordx4 v[12:15], v2, s[32:35], s40 offen sc1
    s_bitcmp1_b32 s2, 0
    s_cbranch_scc1 L_p0_tu
    buffer_load_dword a254, v31, s[16:19], s38 offen
    s_branch L_p0_td
L_p0_tu:
    buffer_load_dword a254, v31, s[20:23], s38 offen
L_p0_td:
    s_lshl_b32 s38, s2, 2
    s_add_u32 s38, s38, s36
    s_lshr_b32 s43, s38, 9
    s_mul_i32 s43, s43, 917504
    s_and_b32 s38, s38, 511
    s_lshl_b32 s38, s38, 7
    s_add_u32 s38, s38, s43
    s_add_u32 s38, s38, 851968
    v_lshlrev_b32 v31, 7, v1
    s_mov_b64 exec, 1
    buffer_load_dword a253, v31, s[24:27], s38 offen
    s_mov_b64 exec, -1
    s_waitcnt lgkmcnt(0)
    ds_read_b64_tr_b16 v[16:17], v24 offset:0
    ds_read_b64_tr_b16 v[18:19], v24 offset:128
    ds_read_b64_tr_b16 v[20:21], v24 offset:512
    ds_read_b64_tr_b16 v[22:23], v24 offset:640
    s_lshl_b32 s44, s2, 4
    s_add_u32 s44, s44, 0x1101000
    s_waitcnt lgkmcnt(2)
    v_mfma_f32_32x32x16_bf16 v[32:47], v[16:19], v[64:67], 0
    v_mfma_f32_32x32x16_bf16 v[48:63], v[16:19], v[72:75], 0
    s_waitcnt lgkmcnt(0)
    v_mfma_f32_32x32x16_bf16 v[32:47], v[20:23], v[68:71], v[32:47]
    v_mfma_f32_32x32x16_bf16 v[48:63], v[20:23], v[76:79], v[48:63]
    v_cvt_f32_u32 v30, v3
    v_mul_f32 v30, 4.0, v30
    v_and_b32 v6, 7, v4
    v_cvt_f32_u32 v6, v6
    v_mul_f32 v7, 0x3d800000, v6
    v_bfe_u32 v6, v4, 3, 1
    v_cvt_f32_u32 v6, v6
    v_mul_f32 v6, 0x3e800000, v6
    v_fma_f32 v6, v30, v7, v6
    v_mul_f32 v31, 4.0, v7
    v_cmp_gt_u32 vcc, 16, v4
    v_add_f32 v121, v6, v7
    v_cos_f32 v122, v6
    v_cos_f32 v123, v121
    v_sin_f32 v120, v6
    v_add_f32 v6, v121, v7
    v_sin_f32 v121, v121
    v_cvt_pk_bf16_f32 v122, v122, v123
    v_cvt_pk_bf16_f32 v120, v120, v121
    v_cndmask_b32 v96, 0, v122, vcc
    v_cndmask_b32 v100, 0, v120, vcc
    v_cndmask_b32 v104, v122, 0, vcc
    v_cndmask_b32 v108, v120, 0, vcc
    v_add_f32 v121, v6, v7
    v_cos_f32 v122, v6
    v_cos_f32 v123, v121
    v_sin_f32 v120, v6
    v_add_f32 v6, v121, v7
    v_sin_f32 v121, v121
    v_add_f32 v6, v6, v31
    v_cvt_pk_bf16_f32 v122, v122, v123
    v_cvt_pk_bf16_f32 v120, v120, v121
    v_cndmask_b32 v97, 0, v122, vcc
    v_cndmask_b32 v101, 0, v120, vcc
    v_cndmask_b32 v105, v122, 0, vcc
    v_cndmask_b32 v109, v120, 0, vcc
    v_add_f32 v121, v6, v7
    v_cos_f32 v122, v6
    v_cos_f32 v123, v121
    v_sin_f32 v120, v6
    v_add_f32 v6, v121, v7
    v_sin_f32 v121, v121
    v_cvt_pk_bf16_f32 v122, v122, v123
    v_cvt_pk_bf16_f32 v120, v120, v121
    v_cndmask_b32 v98, 0, v122, vcc
    v_cndmask_b32 v102, 0, v120, vcc
    v_cndmask_b32 v106, v122, 0, vcc
    v_cndmask_b32 v110, v120, 0, vcc
    v_add_f32 v121, v6, v7
    v_cos_f32 v122, v6
    v_cos_f32 v123, v121
    v_sin_f32 v120, v6
    v_sin_f32 v121, v121
    v_cvt_pk_bf16_f32 v122, v122, v123
    v_cvt_pk_bf16_f32 v120, v120, v121
    v_cndmask_b32 v99, 0, v122, vcc
    v_cndmask_b32 v103, 0, v120, vcc
    v_cndmask_b32 v107, v122, 0, vcc
    v_cndmask_b32 v111, v120, 0, vcc
    v_pk_mul_f32 v[120:121], v[32:33], v[80:81]
    v_pk_mul_f32 v[122:123], v[48:49], v[80:81]
    v_pk_fma_f32 v[120:121], v[48:49], v[88:89], v[120:121]
    v_pk_fma_f32 v[122:123], v[32:33], v[88:89], v[122:123] neg_lo:[1,0,0] neg_hi:[1,0,0]
    v_cvt_pk_bf16_f32 v8, v120, v121
    v_cvt_pk_bf16_f32 v12, v122, v123
    v_pk_mul_f32 v[120:121], v[34:35], v[82:83]
    v_pk_mul_f32 v[122:123], v[50:51], v[82:83]
    v_pk_fma_f32 v[120:121], v[50:51], v[90:91], v[120:121]
    v_pk_fma_f32 v[122:123], v[34:35], v[90:91], v[122:123] neg_lo:[1,0,0] neg_hi:[1,0,0]
    v_cvt_pk_bf16_f32 v9, v120, v121
    v_cvt_pk_bf16_f32 v13, v122, v123
    v_pk_mul_f32 v[120:121], v[36:37], v[84:85]
    v_pk_mul_f32 v[122:123], v[52:53], v[84:85]
    v_pk_fma_f32 v[120:121], v[52:53], v[92:93], v[120:121]
    v_pk_fma_f32 v[122:123], v[36:37], v[92:93], v[122:123] neg_lo:[1,0,0] neg_hi:[1,0,0]
    v_cvt_pk_bf16_f32 v10, v120, v121
    v_cvt_pk_bf16_f32 v14, v122, v123
    v_pk_mul_f32 v[120:121], v[38:39], v[86:87]
    v_pk_mul_f32 v[122:123], v[54:55], v[86:87]
    v_pk_fma_f32 v[120:121], v[54:55], v[94:95], v[120:121]
    v_pk_fma_f32 v[122:123], v[38:39], v[94:95], v[122:123] neg_lo:[1,0,0] neg_hi:[1,0,0]
    v_cvt_pk_bf16_f32 v11, v120, v121
    v_cvt_pk_bf16_f32 v15, v122, v123
    v_pk_mul_f32 v[120:121], v[40:41], v[80:81]
    v_pk_mul_f32 v[122:123], v[56:57], v[80:81]
    v_pk_fma_f32 v[120:121], v[56:57], v[88:89], v[120:121]
    v_pk_fma_f32 v[122:123], v[40:41], v[88:89], v[122:123] neg_lo:[1,0,0] neg_hi:[1,0,0]
    v_cvt_pk_bf16_f32 v16, v120, v121
    v_cvt_pk_bf16_f32 v20, v122, v123
    v_pk_mul_f32 v[120:121], v[42:43], v[82:83]
    v_pk_mul_f32 v[122:123], v[58:59], v[82:83]
    v_pk_fma_f32 v[120:121], v[58:59], v[90:91], v[120:121]
    v_pk_fma_f32 v[122:123], v[42:43], v[90:91], v[122:123] neg_lo:[1,0,0] neg_hi:[1,0,0]
    v_cvt_pk_bf16_f32 v17, v120, v121
    v_cvt_pk_bf16_f32 v21, v122, v123
    v_pk_mul_f32 v[120:121], v[44:45], v[84:85]
    v_pk_mul_f32 v[122:123], v[60:61], v[84:85]
    v_pk_fma_f32 v[120:121], v[60:61], v[92:93], v[120:121]
    v_pk_fma_f32 v[122:123], v[44:45], v[92:93], v[122:123] neg_lo:[1,0,0] neg_hi:[1,0,0]
    v_cvt_pk_bf16_f32 v18, v120, v121
    v_cvt_pk_bf16_f32 v22, v122, v123
    v_pk_mul_f32 v[120:121], v[46:47], v[86:87]
    v_pk_mul_f32 v[122:123], v[62:63], v[86:87]
    v_pk_fma_f32 v[120:121], v[62:63], v[94:95], v[120:121]
    v_pk_fma_f32 v[122:123], v[46:47], v[94:95], v[122:123] neg_lo:[1,0,0] neg_hi:[1,0,0]
    v_cvt_pk_bf16_f32 v19, v120, v121
    v_cvt_pk_bf16_f32 v23, v122, v123
    v_mfma_f32_32x32x16_bf16 v[32:47], v[96:99], v[8:11], 0
    v_mfma_f32_32x32x16_bf16 v[32:47], v[100:103], v[12:15], v[32:47]
    v_mfma_f32_32x32x16_bf16 v[32:47], v[104:107], v[16:19], v[32:47]
    v_mfma_f32_32x32x16_bf16 v[32:47], v[108:111], v[20:23], v[32:47]
    s_lshl_b32 s46, s36, 7
    s_add_u32 s46, s46, s48
    s_add_u32 s46, s46, 124928
    v_and_b32 v6, 1, v1
    v_lshlrev_b32 v7, 13, v6
    v_and_b32 v5, 62, v1
    v_add3_u32 v7, v7, v5, s46
    s_lshl_b32 s47, s36, 12
    s_add_u32 s46, s47, 108544
    v_lshlrev_b32 v5, 5, v5
    v_bfe_u32 v30, v1, 2, 2
    v_or_b32 v6, 2, v6
    v_xor_b32 v6, v6, v30
    v_lshl_add_u32 v5, v6, 4, v5
    v_add_u32 v5, s46, v5
    v_xor_b32 v26, 16, v25
    s_lshr_b32 s46, s2, 3
    s_cmp_lt_u32 s46, 28
    s_cselect_b32 s50, 1, 0
    s_cselect_b32 s96, 0, 0x40000000
    s_mul_i32 s47, s46, 37
    s_lshr_b32 s47, s47, 8
    s_mul_i32 s48, s47, 7
    s_sub_u32 s48, s46, s48
    s_bfe_u32 s49, s2, 0x20001
    s_lshl_b32 s49, s49, 2
    s_add_u32 s38, s49, s47
    s_and_b32 s49, s2, 1
    s_mul_i32 s49, s49, 7
    s_add_u32 s39, s49, s48
    s_and_b32 s49, s2, 7
    s_lshl_b32 s49, s49, 5
    s_add_u32 s49, s49, s46
    s_lshl_b32 s45, s49, 4
    v_lshlrev_b32 v10, 4, v1
    v_lshrrev_b32 v11, 4, v1
    v_lshlrev_b32 v12, 6, v11
    v_xor_b32 v12, v12, v10
    v_and_b32 v12, 0xff, v12
    v_mul_u32_u24 v11, 3584, v11
    v_add_u32 v9, v11, v12
    s_lshl_b32 s42, s39, 8
    s_mul_i32 s47, s36, 14336
    s_add_u32 s42, s42, s47
    s_add_u32 s42, s42, s96
    s_lshl_b32 s43, s36, 10
    s_lshr_b32 s40, s38, 1
    s_lshl_b32 s40, s40, 18
    s_and_b32 s47, s38, 1
    s_lshl_b32 s47, s47, 14
    s_add_u32 s40, s40, s47
    s_and_b32 s47, s36, 1
    s_lshl_b32 s47, s47, 17
    s_add_u32 s40, s40, s47
    s_lshr_b32 s47, s36, 1
    s_lshl_b32 s47, s47, 13
    s_add_u32 s40, s40, s47
    s_add_u32 s40, s40, 0x800000
    s_lshl_b32 s41, s36, 12
    s_lshl_b32 s47, s36, 12
    s_waitcnt vmcnt(2)
    v_readfirstlane_b32 s37, v119
    s_barrier
    s_mul_i32 s37, s37, 0x9E3779B1
    s_add_u32 s37, s37, 0x7F4A7C15
    s_cmp_lg_u32 s36, 0
    s_cbranch_scc1 L_p0_s1
    v_mov_b32 v124, s37
    v_mov_b32 v125, 0
    s_mov_b64 exec, 1
    buffer_store_dword v124, v125, s[32:35], s44 offen sc1
    s_mov_b64 exec, -1
L_p0_s1:
    s_add_u32 m0, s43, 16384
    s_add_u32 s46, s42, 0
    buffer_load_dwordx4 v9, s[16:19], s46 offen lds
    s_add_u32 m0, s43, 20480
    s_add_u32 s46, s42, 0
    buffer_load_dwordx4 v9, s[20:23], s46 offen lds
    s_add_u32 m0, s43, 24576
    s_add_u32 s46, s42, 57344
    buffer_load_dwordx4 v9, s[16:19], s46 offen lds
    s_add_u32 m0, s43, 28672
    s_add_u32 s46, s42, 57344
    buffer_load_dwordx4 v9, s[20:23], s46 offen lds
    ds_read_u16 v96, v7 offset:0
    ds_read_u16 v104, v7 offset:1024
    ds_read_u16 v97, v7 offset:2048
    ds_read_u16 v105, v7 offset:3072
    ds_read_u16 v98, v7 offset:4096
    ds_read_u16 v106, v7 offset:5120
    ds_read_u16 v99, v7 offset:6144
    ds_read_u16 v107, v7 offset:7168
    ds_read_u16 v100, v7 offset:64
    ds_read_u16 v108, v7 offset:1088
    ds_read_u16 v101, v7 offset:2112
    ds_read_u16 v109, v7 offset:3136
    ds_read_u16 v102, v7 offset:4160
    ds_read_u16 v110, v7 offset:5184
    ds_read_u16 v103, v7 offset:6208
    ds_read_u16 v111, v7 offset:7232
    v_cvt_pk_bf16_f32 v48, v32, v40
    ds_write_b32 v25, v48 offset:0
    v_cvt_pk_bf16_f32 v49, v33, v41
    ds_write_b32 v25, v49 offset:2048
    v_cvt_pk_bf16_f32 v50, v34, v42
    ds_write_b32 v25, v50 offset:4096
    v_cvt_pk_bf16_f32 v51, v35, v43
    ds_write_b32 v25, v51 offset:6144
    v_cvt_pk_bf16_f32 v52, v36, v44
    ds_write_b32 v26, v52 offset:0
    v_cvt_pk_bf16_f32 v53, v37, v45
    ds_write_b32 v26, v53 offset:2048
    v_cvt_pk_bf16_f32 v54, v38, v46
    ds_write_b32 v26, v54 offset:4096
    v_cvt_pk_bf16_f32 v55, v39, v47
    ds_write_b32 v26, v55 offset:6144
    s_add_u32 m0, s43, 32768
    s_add_u32 s46, s42, 114688
    buffer_load_dwordx4 v9, s[16:19], s46 offen lds
    s_add_u32 m0, s43, 36864
    s_add_u32 s46, s42, 114688
    buffer_load_dwordx4 v9, s[20:23], s46 offen lds
    s_lshr_b32 s101, s2, 1
    s_lshl_b32 s101, s101, 11
    s_and_b32 s46, s2, 1
    s_lshl_b32 s46, s46, 6
    s_add_u32 s101, s101, s46
    v_lshrrev_b32 v113, 2, v1
    v_and_b32 v112, 3, v1
    v_lshlrev_b32 v112, 4, v112
    v_lshl_add_u32 v113, v113, 7, v112
    s_mul_i32 s46, s36, 1049088
    s_add_u32 s101, s101, s46
    s_add_u32 s101, s101, 0xa00000
    v_bfe_u32 v6, v1, 3, 2
    v_lshlrev_b32 v6, 4, v6
    v_xor_b32 v6, v6, v28
    v_add_u32 v6, s47, v6
    s_waitcnt lgkmcnt(8)
    v_lshl_or_b32 v96, v104, 16, v96
    v_lshl_or_b32 v97, v105, 16, v97
    v_lshl_or_b32 v98, v106, 16, v98
    v_lshl_or_b32 v99, v107, 16, v99
    v_lshl_or_b32 v100, v108, 16, v100
    v_lshl_or_b32 v101, v109, 16, v101
    v_lshl_or_b32 v102, v110, 16, v102
    v_lshl_or_b32 v103, v111, 16, v103
    ds_write_b128 v5, v[96:99]
    ds_write_b128 v5, v[100:103] offset:2048
    s_waitcnt lgkmcnt(0)
    s_barrier
    ds_read_b128 v[96:99], v6 offset:10240
    ds_read_b128 v[100:103], v6 offset:11264
    ds_read_b128 v[104:107], v6 offset:12288
    ds_read_b128 v[108:111], v6 offset:13312
    v_lshrrev_b32 v11, 3, v1
    v_and_b32 v12, 7, v1
    v_lshrrev_b32 v13, 4, v1
    v_xor_b32 v12, v12, v13
    v_lshlrev_b32 v12, 4, v12
    v_lshl_add_u32 v7, v11, 10, v12
    v_xor_b32 v8, 64, v7
    v_and_b32 v118, 15, v1
    s_add_u32 m0, s43, 40960
    s_add_u32 s46, s42, 172032
    buffer_load_dwordx4 v9, s[16:19], s46 offen lds
    s_lshl_b32 s48, s36, 4
    v_add_u32 v118, s48, v118
    v_cvt_f32_u32 v118, v118
    v_mul_f32 v119, 0x3c800000, v118
    v_lshrrev_b32 v120, 5, v1
    v_cvt_f32_u32 v120, v120
    v_mul_f32 v120, 0x41000000, v120
    v_bfe_u32 v121, v1, 4, 1
    s_add_u32 m0, s43, 45056
    s_add_u32 s46, s42, 172032
    buffer_load_dwordx4 v9, s[20:23], s46 offen lds
    v_cvt_f32_u32 v121, v121
    v_mul_f32 v121, 0xbe800000, v121
    v_fma_f32 v121, v120, v119, v121
    v_add_f32 v115, v121, v119
    v_cos_f32 v116, v121
    v_cos_f32 v117, v115
    v_sin_f32 v114, v121
    v_add_f32 v121, v115, v119
    s_add_u32 m0, s43, 65536
    s_add_u32 s46, s42, 229376
    buffer_load_dwordx4 v9, s[16:19], s46 offen lds
    v_sin_f32 v115, v115
    v_cvt_pk_bf16_f32 v24, v116, v117
    v_cvt_pk_bf16_f32 v40, -v114, -v115
    v_add_f32 v115, v121, v119
    v_cos_f32 v116, v121
    v_cos_f32 v117, v115
    v_sin_f32 v114, v121
    v_add_f32 v121, v115, v119
    s_add_u32 m0, s43, 69632
    s_add_u32 s46, s42, 229376
    buffer_load_dwordx4 v9, s[20:23], s46 offen lds
    v_sin_f32 v115, v115
    v_cvt_pk_bf16_f32 v25, v116, v117
    v_cvt_pk_bf16_f32 v41, -v114, -v115
    v_add_f32 v115, v121, v119
    v_cos_f32 v116, v121
    v_cos_f32 v117, v115
    v_sin_f32 v114, v121
    v_add_f32 v121, v115, v119
    s_add_u32 m0, s43, 73728
    s_add_u32 s46, s42, 286720
    buffer_load_dwordx4 v9, s[16:19], s46 offen lds
    v_sin_f32 v115, v115
    v_cvt_pk_bf16_f32 v26, v116, v117
    v_cvt_pk_bf16_f32 v42, -v114, -v115
    v_add_f32 v115, v121, v119
    v_cos_f32 v116, v121
    v_cos_f32 v117, v115
    v_sin_f32 v114, v121
    s_add_u32 m0, s43, 77824
    s_add_u32 s46, s42, 286720
    buffer_load_dwordx4 v9, s[20:23], s46 offen lds
    s_cmp_eq_u32 s50, 0
    s_cbranch_scc1 L_noB
    v_and_b32 v15, 31, v1
    v_lshlrev_b32 v15, 4, v15
    s_lshr_b32 s51, s38, 1
    s_lshl_b32 s51, s51, 9
    s_add_u32 s51, s51, 0x1101000
    buffer_load_dword v126, v15, s[32:35], s51 offen sc1
    v_sin_f32 v115, v115
    v_cvt_pk_bf16_f32 v27, v116, v117
    v_cvt_pk_bf16_f32 v43, -v114, -v115
    v_and_b32 v114, 1, v1
    v_cmp_eq_u32 vcc, 1, v114
    v_mul_u32_u24 v119, 0x8000, v114
    v_lshl_or_b32 v119, v119, 16, v119
    v_bfe_u32 v115, v1, 1, 1
    v_mul_u32_u24 v120, 0x8000, v115
    v_lshl_or_b32 v120, v120, 16, v120
    v_xor_b32 v121, v119, v120
    v_cndmask_b32 v116, v24, v40, vcc
    v_cndmask_b32 v117, v40, v24, vcc
    v_xor_b32 v28, v116, v120
    v_xor_b32 v44, v117, v121
    v_cndmask_b32 v116, v25, v41, vcc
    v_cndmask_b32 v117, v41, v25, vcc
    v_xor_b32 v29, v116, v120
    v_xor_b32 v45, v117, v121
    s_add_u32 m0, s43, 81920
    s_add_u32 s46, s42, 344064
    buffer_load_dwordx4 v9, s[16:19], s46 offen lds
    v_cndmask_b32 v116, v26, v42, vcc
    v_cndmask_b32 v117, v42, v26, vcc
    v_xor_b32 v30, v116, v120
    v_xor_b32 v46, v117, v121
    v_cndmask_b32 v116, v27, v43, vcc
    v_cndmask_b32 v117, v43, v27, vcc
    v_xor_b32 v31, v116, v120
    v_xor_b32 v47, v117, v121
    v_xor_b32 v32, v24, v119
    v_xor_b32 v48, v40, v119
    v_xor_b32 v33, v25, v119
    v_xor_b32 v49, v41, v119
    v_xor_b32 v34, v26, v119
    v_xor_b32 v50, v42, v119
    v_xor_b32 v35, v27, v119
    v_xor_b32 v51, v43, v119
    v_xor_b32 v36, v28, v119
    v_xor_b32 v52, v44, v119
    v_xor_b32 v37, v29, v119
    s_add_u32 m0, s43, 86016
    s_add_u32 s46, s42, 344064
    buffer_load_dwordx4 v9, s[20:23], s46 offen lds
    v_xor_b32 v53, v45, v119
    v_xor_b32 v38, v30, v119
    v_xor_b32 v54, v46, v119
    v_xor_b32 v39, v31, v119
    v_xor_b32 v55, v47, v119
    v_accvgpr_write_b32 a80, v24
    v_accvgpr_write_b32 a81, v25
    v_accvgpr_write_b32 a82, v26
    v_accvgpr_write_b32 a83, v27
    v_accvgpr_write_b32 a84, v28
    v_accvgpr_write_b32 a85, v29
    v_accvgpr_write_b32 a86, v30
    v_accvgpr_write_b32 a87, v31
    v_accvgpr_write_b32 a88, v32
    v_accvgpr_write_b32 a89, v33
    v_accvgpr_write_b32 a90, v34
    v_accvgpr_write_b32 a91, v35
    v_accvgpr_write_b32 a92, v36
    v_accvgpr_write_b32 a93, v37
    s_add_u32 m0, s43, 90112
    s_add_u32 s46, s42, 401408
    buffer_load_dwordx4 v9, s[16:19], s46 offen lds
    v_accvgpr_write_b32 a94, v38
    v_accvgpr_write_b32 a95, v39
    v_accvgpr_write_b32 a96, v40
    v_accvgpr_write_b32 a97, v41
    v_accvgpr_write_b32 a98, v42
    v_accvgpr_write_b32 a99, v43
    v_accvgpr_write_b32 a100, v44
    v_accvgpr_write_b32 a101, v45
    v_accvgpr_write_b32 a102, v46
    v_accvgpr_write_b32 a103, v47
    v_accvgpr_write_b32 a104, v48
    v_accvgpr_write_b32 a105, v49
    v_accvgpr_write_b32 a106, v50
    v_accvgpr_write_b32 a107, v51
    v_accvgpr_write_b32 a108, v52
    v_accvgpr_write_b32 a109, v53
    v_accvgpr_write_b32 a110, v54
    v_accvgpr_write_b32 a111, v55
    s_add_u32 m0, s43, 94208
    s_add_u32 s46, s42, 401408
    buffer_load_dwordx4 v9, s[20:23], s46 offen lds
    s_waitcnt vmcnt(4)
    v_cmp_ne_u32 vcc, s37, v126
    s_nop 1
    s_cbranch_vccnz L_s1_spin
L_s1_ok:
    s_add_u32 m0, s41, 0
    s_add_u32 s46, s40, 0
    buffer_load_dwordx4 v7, s[32:35], s46 offen sc1 lds
    s_add_u32 m0, s41, 1024
    s_add_u32 s46, s40, 32768
    buffer_load_dwordx4 v8, s[32:35], s46 offen sc1 lds
    s_add_u32 m0, s41, 2048
    s_add_u32 s46, s40, 65536
    buffer_load_dwordx4 v7, s[32:35], s46 offen sc1 lds
    s_add_u32 m0, s41, 3072
    s_add_u32 s46, s40, 98304
    buffer_load_dwordx4 v8, s[32:35], s46 offen sc1 lds
    s_add_u32 m0, s41, 49152
    s_add_u32 s46, s40, 128
    buffer_load_dwordx4 v7, s[32:35], s46 offen sc1 lds
    s_add_u32 m0, s41, 50176
    s_add_u32 s46, s40, 32896
    buffer_load_dwordx4 v8, s[32:35], s46 offen sc1 lds
    s_add_u32 m0, s41, 51200
    s_add_u32 s46, s40, 65664
    buffer_load_dwordx4 v7, s[32:35], s46 offen sc1 lds
    s_add_u32 m0, s41, 52224
    s_add_u32 s46, s40, 98432
    buffer_load_dwordx4 v8, s[32:35], s46 offen sc1 lds
    s_waitcnt lgkmcnt(0)
    buffer_store_dwordx4 v[96:99], v113, s[32:35], s101 offen sc1
    s_add_u32 s101, s101, 262272
    buffer_store_dwordx4 v[100:103], v113, s[32:35], s101 offen sc1
    s_add_u32 s101, s101, 262272
    buffer_store_dwordx4 v[104:107], v113, s[32:35], s101 offen sc1
    s_add_u32 s101, s101, 262272
    buffer_store_dwordx4 v[108:111], v113, s[32:35], s101 offen sc1
    v_and_b32 v11, 31, v1
    v_lshrrev_b32 v12, 5, v1
    v_bfe_u32 v13, v1, 1, 3
    v_or_b32 v14, 0, v12
    v_xor_b32 v14, v14, v13
    v_lshlrev_b32 v14, 4, v14
    v_lshl_add_u32 v2, v11, 7, v14
    v_or_b32 v14, 2, v12
    v_xor_b32 v14, v14, v13
    v_lshlrev_b32 v14, 4, v14
    v_lshl_add_u32 v3, v11, 7, v14
    v_or_b32 v14, 4, v12
    v_xor_b32 v14, v14, v13
    v_lshlrev_b32 v14, 4, v14
    v_lshl_add_u32 v4, v11, 7, v14
    v_or_b32 v14, 6, v12
    v_xor_b32 v14, v14, v13
    v_lshlrev_b32 v14, 4, v14
    v_lshl_add_u32 v5, v11, 7, v14
    v_lshlrev_b32 v14, 11, v12
    v_bfe_u32 v13, v1, 2, 2
    v_lshl_add_u32 v14, v13, 8, v14
    v_xor_b32 v13, s36, v13
    v_lshl_add_u32 v14, v13, 6, v14
    v_bfe_u32 v13, v1, 4, 1
    v_lshl_add_u32 v14, v13, 5, v14
    v_and_b32 v13, 1, v1
    v_lshl_add_u32 v14, v13, 4, v14
    v_bfe_u32 v13, v1, 1, 1
    v_lshl_add_u32 v6, v13, 3, v14
    s_waitcnt vmcnt(8)
    s_barrier
    ds_read_b64_tr_b16 a[32:33], v6 offset:16384
    ds_read_b64_tr_b16 a[34:35], v6 offset:17408
    ds_read_b64_tr_b16 a[36:37], v6 offset:20480
    ds_read_b64_tr_b16 a[38:39], v6 offset:21504
    ds_read_b128 a[0:3], v2 offset:0
    ds_read_b128 a[4:7], v2 offset:4096
    ds_read_b128 a[8:11], v2 offset:8192
    ds_read_b128 a[12:15], v2 offset:12288
    s_lshl_b32 s101, s2, 2
    s_add_u32 s101, s101, 0x1109000
    s_waitcnt lgkmcnt(0)
    v_mfma_f32_32x32x16_bf16 v[128:143], a[32:35], a[0:3], 0
    ds_read_b64_tr_b16 a[40:41], v6 offset:24576
    ds_read_b64_tr_b16 a[42:43], v6 offset:25600
    v_lshlrev_b32 v12, 2, v1
    v_and_b32 v12, 64, v12
    v_mfma_f32_32x32x16_bf16 v[144:159], a[36:39], a[0:3], 0
    ds_read_b64_tr_b16 a[44:45], v6 offset:28672
    ds_read_b64_tr_b16 a[46:47], v6 offset:29696
    ds_read_b128 a[16:19], v3 offset:0
    v_xor_b32 v12, v12, v10
    v_and_b32 v12, 127, v12
    v_mfma_f32_32x32x16_bf16 v[160:175], a[32:35], a[4:7], 0
    ds_read_b128 a[20:23], v3 offset:4096
    ds_read_b128 a[24:27], v3 offset:8192
    v_lshrrev_b32 v13, 3, v1
    v_mfma_f32_32x32x16_bf16 v[176:191], a[36:39], a[4:7], 0
    ds_read_b128 a[28:31], v3 offset:12288
    v_lshl_add_u32 v11, v13, 10, v12
    s_and_b32 s48, s36, 1
    v_mfma_f32_32x32x16_bf16 v[192:207], a[32:35], a[8:11], 0
    s_add_u32 m0, s43, 114688
    s_add_u32 s46, s42, 458752
    buffer_load_dwordx4 v9, s[16:19], s46 offen lds
    s_mul_i32 s57, s48, 917504
    s_lshl_b32 s58, s48, 13
    v_mfma_f32_32x32x16_bf16 v[208:223], a[36:39], a[8:11], 0
    s_add_u32 m0, s43, 118784
    s_add_u32 s46, s42, 458752
    buffer_load_dwordx4 v9, s[20:23], s46 offen lds
    s_bfe_u32 s48, s2, 0x30003
    v_mfma_f32_32x32x16_bf16 v[224:239], a[32:35], a[12:15], 0
    s_add_u32 m0, s41, 98304
    s_add_u32 s46, s40, 256
    buffer_load_dwordx4 v7, s[32:35], s46 offen sc1 lds
    s_lshl_b32 s48, s48, 7
    s_add_u32 s57, s57, s48
    v_mfma_f32_32x32x16_bf16 v[240:255], a[36:39], a[12:15], 0
    s_lshr_b32 s48, s36, 1
    s_waitcnt lgkmcnt(0)
    v_mfma_f32_32x32x16_bf16 v[128:143], a[40:43], a[16:19], v[128:143]
    ds_read_b64_tr_b16 a[32:33], v6 offset:32768
    ds_read_b64_tr_b16 a[34:35], v6 offset:33792
    s_lshl_b32 s48, s48, 13
    s_add_u32 s57, s57, s48
    v_mfma_f32_32x32x16_bf16 v[144:159], a[44:47], a[16:19], v[144:159]
    ds_read_b64_tr_b16 a[36:37], v6 offset:36864
    ds_read_b64_tr_b16 a[38:39], v6 offset:37888
    ds_read_b128 a[0:3], v4 offset:0
    s_lshr_b32 s48, s48, 3
    s_add_u32 s58, s58, s48
    v_mfma_f32_32x32x16_bf16 v[160:175], a[40:43], a[20:23], v[160:175]
    ds_read_b128 a[4:7], v4 offset:4096
    ds_read_b128 a[8:11], v4 offset:8192
    v_lshrrev_b32 v12, 5, v1
    v_mfma_f32_32x32x16_bf16 v[176:191], a[44:47], a[20:23], v[176:191]
    ds_read_b128 a[12:15], v4 offset:12288
    v_lshlrev_b32 v16, 10, v12
    v_bfe_u32 v12, v1, 2, 2
    v_mfma_f32_32x32x16_bf16 v[192:207], a[40:43], a[24:27], v[192:207]
    s_add_u32 m0, s43, 122880
    s_add_u32 s46, s42, 516096
    buffer_load_dwordx4 v9, s[16:19], s46 offen lds
    v_lshl_add_u32 v16, v12, 7, v16
    v_bfe_u32 v12, v1, 3, 1
    v_mfma_f32_32x32x16_bf16 v[208:223], a[44:47], a[24:27], v[208:223]
    s_add_u32 m0, s43, 126976
    s_add_u32 s46, s42, 516096
    buffer_load_dwordx4 v9, s[20:23], s46 offen lds
    v_lshl_add_u32 v16, v12, 6, v16
    v_mfma_f32_32x32x16_bf16 v[224:239], a[40:43], a[28:31], v[224:239]
    s_add_u32 m0, s41, 99328
    s_add_u32 s46, s40, 33024
    buffer_load_dwordx4 v8, s[32:35], s46 offen sc1 lds
    v_mov_b32 v22, v16
    v_bfe_u32 v12, v1, 4, 1
    v_mfma_f32_32x32x16_bf16 v[240:255], a[44:47], a[28:31], v[240:255]
    v_lshl_add_u32 v16, v12, 4, v16
    s_waitcnt lgkmcnt(0)
    v_mfma_f32_32x32x16_bf16 v[128:143], a[32:35], a[0:3], v[128:143]
    ds_read_b64_tr_b16 a[40:41], v6 offset:40960
    ds_read_b64_tr_b16 a[42:43], v6 offset:41984
    v_and_b32 v12, 1, v1
    v_lshl_add_u32 v16, v12, 5, v16
    v_mfma_f32_32x32x16_bf16 v[144:159], a[36:39], a[0:3], v[144:159]
    ds_read_b64_tr_b16 a[44:45], v6 offset:45056
    ds_read_b64_tr_b16 a[46:47], v6 offset:46080
    ds_read_b128 a[16:19], v5 offset:0
    v_bfe_u32 v12, v1, 1, 1
    v_mfma_f32_32x32x16_bf16 v[160:175], a[32:35], a[4:7], v[160:175]
    ds_read_b128 a[20:23], v5 offset:4096
    ds_read_b128 a[24:27], v5 offset:8192
    v_lshl_add_u32 v16, v12, 3, v16
    s_and_b32 s48, s36, 1
    v_mfma_f32_32x32x16_bf16 v[176:191], a[36:39], a[4:7], v[176:191]
    ds_read_b128 a[28:31], v5 offset:12288
    s_mul_i32 s48, s48, 8256
    v_mfma_f32_32x32x16_bf16 v[192:207], a[32:35], a[8:11], v[192:207]
    s_add_u32 m0, s43, 131072
    s_add_u32 s46, s42, 573440
    buffer_load_dwordx4 v9, s[16:19], s46 offen lds
    v_xor_b32 v16, s48, v16
    v_xor_b32 v17, 64, v16
    v_mfma_f32_32x32x16_bf16 v[208:223], a[36:39], a[8:11], v[208:223]
    s_add_u32 m0, s43, 135168
    s_add_u32 s46, s42, 573440
    buffer_load_dwordx4 v9, s[20:23], s46 offen lds
    v_add_u32 v18, 0x10000, v16
    v_mfma_f32_32x32x16_bf16 v[224:239], a[32:35], a[12:15], v[224:239]
    s_add_u32 m0, s41, 100352
    s_add_u32 s46, s40, 65792
    buffer_load_dwordx4 v7, s[32:35], s46 offen sc1 lds
    v_add_u32 v19, 0x10000, v17
    v_add_u32 v20, 0x20000, v16
    v_mfma_f32_32x32x16_bf16 v[240:255], a[36:39], a[12:15], v[240:255]
    v_add_u32 v21, 0x20000, v17
    s_waitcnt lgkmcnt(0)
    v_mfma_f32_32x32x16_bf16 v[128:143], a[40:43], a[16:19], v[128:143]
    s_waitcnt vmcnt(9)
    s_barrier
    s_cmp_lg_u32 s36, 0
    s_cbranch_scc1 L_f2a
    v_mov_b32 v124, s37
    v_mov_b32 v125, 0
    s_mov_b64 exec, 1
    buffer_store_dword v124, v125, s[32:35], s101 offen sc1
    s_mov_b64 exec, -1
L_f2a:
    v_add_u32 v6, 0xc000, v6
    v_add_u32 v2, 0xc000, v2
    ds_read_b64_tr_b16 a[32:33], v6 offset:16384
    ds_read_b64_tr_b16 a[34:35], v6 offset:17408
    v_mfma_f32_32x32x16_bf16 v[144:159], a[44:47], a[16:19], v[144:159]
    ds_read_b64_tr_b16 a[36:37], v6 offset:20480
    ds_read_b64_tr_b16 a[38:39], v6 offset:21504
    ds_read_b128 a[0:3], v2 offset:0
    v_mfma_f32_32x32x16_bf16 v[160:175], a[40:43], a[20:23], v[160:175]
    ds_read_b128 a[4:7], v2 offset:4096
    ds_read_b128 a[8:11], v2 offset:8192
    v_mfma_f32_32x32x16_bf16 v[176:191], a[44:47], a[20:23], v[176:191]
    ds_read_b128 a[12:15], v2 offset:12288
    v_add_u32 v3, 0xc000, v3
    v_add_u32 v4, 0xc000, v4
    v_add_u32 v5, 0xc000, v5
    v_mfma_f32_32x32x16_bf16 v[192:207], a[40:43], a[24:27], v[192:207]
    s_add_u32 m0, s43, 139264
    s_add_u32 s46, s42, 630784
    buffer_load_dwordx4 v9, s[16:19], s46 offen lds
    v_mfma_f32_32x32x16_bf16 v[208:223], a[44:47], a[24:27], v[208:223]
    s_add_u32 m0, s43, 143360
    s_add_u32 s46, s42, 630784
    buffer_load_dwordx4 v9, s[20:23], s46 offen lds
    v_mfma_f32_32x32x16_bf16 v[224:239], a[40:43], a[28:31], v[224:239]
    s_add_u32 m0, s41, 101376
    s_add_u32 s46, s40, 98560
    buffer_load_dwordx4 v8, s[32:35], s46 offen sc1 lds
    v_mfma_f32_32x32x16_bf16 v[240:255], a[44:47], a[28:31], v[240:255]
    s_waitcnt lgkmcnt(0)
    v_mfma_f32_32x32x16_bf16 v[128:143], a[32:35], a[0:3], v[128:143]
    ds_read_b64_tr_b16 a[40:41], v6 offset:24576
    ds_read_b64_tr_b16 a[42:43], v6 offset:25600
    v_mfma_f32_32x32x16_bf16 v[144:159], a[36:39], a[0:3], v[144:159]
    ds_read_b64_tr_b16 a[44:45], v6 offset:28672
    ds_read_b64_tr_b16 a[46:47], v6 offset:29696
    ds_read_b128 a[16:19], v3 offset:0
    v_mfma_f32_32x32x16_bf16 v[160:175], a[32:35], a[4:7], v[160:175]
    ds_read_b128 a[20:23], v3 offset:4096
    ds_read_b128 a[24:27], v3 offset:8192
    v_mfma_f32_32x32x16_bf16 v[176:191], a[36:39], a[4:7], v[176:191]
    ds_read_b128 a[28:31], v3 offset:12288
    s_cmp_lg_u32 s36, 0
    s_cbranch_scc1 L_ct1
    s_getpc_b64 s[48:49]
L_pc1:
    s_add_u32 s48, s48, L_b8-L_pc1
    s_addc_u32 s49, s49, 0
    s_lshr_b32 s47, s2, 3
    s_mul_i32 s47, s47, 512
    v_lshl_add_u32 v124, v0, 7, s47
    v_min_u32 v124, L_noB-L_b8-4, v124
    v_mov_b32 v125, 0
    v_lshl_add_u64 v[124:125], v[124:125], 0, s[48:49]
    s_mov_b64 exec, 15
    global_load_dword a252, v[124:125], off
    s_mov_b64 exec, -1
L_ct1:
    v_mfma_f32_32x32x16_bf16 v[192:207], a[32:35], a[8:11], v[192:207]
    s_add_u32 m0, s43, 16384
    s_add_u32 s46, s42, 688128
    buffer_load_dwordx4 v9, s[16:19], s46 offen lds
    v_mfma_f32_32x32x16_bf16 v[208:223], a[36:39], a[8:11], v[208:223]
    s_add_u32 m0, s43, 20480
    s_add_u32 s46, s42, 688128
    buffer_load_dwordx4 v9, s[20:23], s46 offen lds
    v_mfma_f32_32x32x16_bf16 v[224:239], a[32:35], a[12:15], v[224:239]
    s_add_u32 m0, s41, 0
    s_add_u32 s46, s40, 384
    buffer_load_dwordx4 v7, s[32:35], s46 offen sc1 lds
    v_mfma_f32_32x32x16_bf16 v[240:255], a[36:39], a[12:15], v[240:255]
    s_waitcnt lgkmcnt(0)
    v_mfma_f32_32x32x16_bf16 v[128:143], a[40:43], a[16:19], v[128:143]
    ds_read_b64_tr_b16 a[32:33], v6 offset:32768
    ds_read_b64_tr_b16 a[34:35], v6 offset:33792
    v_mfma_f32_32x32x16_bf16 v[144:159], a[44:47], a[16:19], v[144:159]
    ds_read_b64_tr_b16 a[36:37], v6 offset:36864
    ds_read_b64_tr_b16 a[38:39], v6 offset:37888
    ds_read_b128 a[0:3], v4 offset:0
    v_mfma_f32_32x32x16_bf16 v[160:175], a[40:43], a[20:23], v[160:175]
    ds_read_b128 a[4:7], v4 offset:4096
    ds_read_b128 a[8:11], v4 offset:8192
    v_mfma_f32_32x32x16_bf16 v[176:191], a[44:47], a[20:23], v[176:191]
    ds_read_b128 a[12:15], v4 offset:12288
    v_mfma_f32_32x32x16_bf16 v[192:207], a[40:43], a[24:27], v[192:207]
    s_add_u32 m0, s43, 24576
    s_add_u32 s46, s42, 745472
    buffer_load_dwordx4 v9, s[16:19], s46 offen lds
    v_mfma_f32_32x32x16_bf16 v[208:223], a[44:47], a[24:27], v[208:223]
    s_add_u32 m0, s43, 28672
    s_add_u32 s46, s42, 745472
    buffer_load_dwordx4 v9, s[20:23], s46 offen lds
    v_mfma_f32_32x32x16_bf16 v[224:239], a[40:43], a[28:31], v[224:239]
    s_add_u32 m0, s41, 1024
    s_add_u32 s46, s40, 33152
    buffer_load_dwordx4 v8, s[32:35], s46 offen sc1 lds
    v_mfma_f32_32x32x16_bf16 v[240:255], a[44:47], a[28:31], v[240:255]
    s_waitcnt lgkmcnt(0)
    v_mfma_f32_32x32x16_bf16 v[128:143], a[32:35], a[0:3], v[128:143]
    ds_read_b64_tr_b16 a[40:41], v6 offset:40960
    ds_read_b64_tr_b16 a[42:43], v6 offset:41984
    v_mfma_f32_32x32x16_bf16 v[144:159], a[36:39], a[0:3], v[144:159]
    ds_read_b64_tr_b16 a[44:45], v6 offset:45056
    ds_read_b64_tr_b16 a[46:47], v6 offset:46080
    ds_read_b128 a[16:19], v5 offset:0
    v_mfma_f32_32x32x16_bf16 v[160:175], a[32:35], a[4:7], v[160:175]
    ds_read_b128 a[20:23], v5 offset:4096
    ds_read_b128 a[24:27], v5 offset:8192
    v_mfma_f32_32x32x16_bf16 v[176:191], a[36:39], a[4:7], v[176:191]
    ds_read_b128 a[28:31], v5 offset:12288
    v_mfma_f32_32x32x16_bf16 v[192:207], a[32:35], a[8:11], v[192:207]
    s_add_u32 m0, s43, 32768
    s_add_u32 s46, s42, 802816
    buffer_load_dwordx4 v9, s[16:19], s46 offen lds
    v_mfma_f32_32x32x16_bf16 v[208:223], a[36:39], a[8:11], v[208:223]
    s_add_u32 m0, s43, 36864
    s_add_u32 s46, s42, 802816
    buffer_load_dwordx4 v9, s[20:23], s46 offen lds
    v_mfma_f32_32x32x16_bf16 v[224:239], a[32:35], a[12:15], v[224:239]
    s_add_u32 m0, s41, 2048
    s_add_u32 s46, s40, 65920
    buffer_load_dwordx4 v7, s[32:35], s46 offen sc1 lds
    v_mfma_f32_32x32x16_bf16 v[240:255], a[36:39], a[12:15], v[240:255]
    s_waitcnt lgkmcnt(0)
    v_mfma_f32_32x32x16_bf16 v[128:143], a[40:43], a[16:19], v[128:143]
    s_waitcnt vmcnt(9)
    s_barrier
    v_add_u32 v6, 0xc000, v6
    v_add_u32 v2, 0xc000, v2
    ds_read_b64_tr_b16 a[32:33], v6 offset:16384
    ds_read_b64_tr_b16 a[34:35], v6 offset:17408
    v_mfma_f32_32x32x16_bf16 v[144:159], a[44:47], a[16:19], v[144:159]
    ds_read_b64_tr_b16 a[36:37], v6 offset:20480
    ds_read_b64_tr_b16 a[38:39], v6 offset:21504
    ds_read_b128 a[0:3], v2 offset:0
    v_mfma_f32_32x32x16_bf16 v[160:175], a[40:43], a[20:23], v[160:175]
    ds_read_b128 a[4:7], v2 offset:4096
    ds_read_b128 a[8:11], v2 offset:8192
    v_mfma_f32_32x32x16_bf16 v[176:191], a[44:47], a[20:23], v[176:191]
    ds_read_b128 a[12:15], v2 offset:12288
    v_add_u32 v3, 0xc000, v3
    v_add_u32 v4, 0xc000, v4
    v_add_u32 v5, 0xc000, v5
    v_mfma_f32_32x32x16_bf16 v[192:207], a[40:43], a[24:27], v[192:207]
    s_add_u32 m0, s43, 40960
    s_add_u32 s46, s42, 860160
    buffer_load_dwordx4 v9, s[16:19], s46 offen lds
    v_mfma_f32_32x32x16_bf16 v[208:223], a[44:47], a[24:27], v[208:223]
    s_add_u32 m0, s43, 45056
    s_add_u32 s46, s42, 860160
    buffer_load_dwordx4 v9, s[20:23], s46 offen lds
    v_mfma_f32_32x32x16_bf16 v[224:239], a[40:43], a[28:31], v[224:239]
    s_add_u32 m0, s41, 3072
    s_add_u32 s46, s40, 98688
    buffer_load_dwordx4 v8, s[32:35], s46 offen sc1 lds
    v_mfma_f32_32x32x16_bf16 v[240:255], a[44:47], a[28:31], v[240:255]
L_b8:
    s_waitcnt lgkmcnt(0)
    v_mfma_f32_32x32x16_bf16 v[128:143], a[32:35], a[0:3], v[128:143]
    ds_read_b64_tr_b16 a[40:41], v6 offset:24576
    ds_read_b64_tr_b16 a[42:43], v6 offset:25600
    v_mfma_f32_32x32x16_bf16 v[144:159], a[36:39], a[0:3], v[144:159]
    ds_read_b64_tr_b16 a[44:45], v6 offset:28672
    ds_read_b64_tr_b16 a[46:47], v6 offset:29696
    ds_read_b128 a[16:19], v3 offset:0
    v_mfma_f32_32x32x16_bf16 v[160:175], a[32:35], a[4:7], v[160:175]
    ds_read_b128 a[20:23], v3 offset:4096
    ds_read_b128 a[24:27], v3 offset:8192
    v_mfma_f32_32x32x16_bf16 v[176:191], a[36:39], a[4:7], v[176:191]
    ds_read_b128 a[28:31], v3 offset:12288
    s_add_u32 m0, s58, 147456
    s_add_u32 s47, s57, 851968
    buffer_load_dwordx4 v11, s[24:27], s47 offen lds
    v_mfma_f32_32x32x16_bf16 v[192:207], a[32:35], a[8:11], v[192:207]
    s_add_u32 m0, s43, 65536
    s_add_u32 s46, s42, 917504
    buffer_load_dwordx4 v9, s[16:19], s46 offen lds
    v_mfma_f32_32x32x16_bf16 v[208:223], a[36:39], a[8:11], v[208:223]
    s_add_u32 m0, s43, 69632
    s_add_u32 s46, s42, 917504
    buffer_load_dwordx4 v9, s[20:23], s46 offen lds
    v_mfma_f32_32x32x16_bf16 v[224:239], a[32:35], a[12:15], v[224:239]
    s_add_u32 m0, s41, 49152
    s_add_u32 s46, s40, 512
    buffer_load_dwordx4 v7, s[32:35], s46 offen sc1 lds
    v_mfma_f32_32x32x16_bf16 v[240:255], a[36:39], a[12:15], v[240:255]
    s_waitcnt lgkmcnt(0)
    v_mfma_f32_32x32x16_bf16 v[128:143], a[40:43], a[16:19], v[128:143]
    ds_read_b64_tr_b16 a[32:33], v6 offset:32768
    ds_read_b64_tr_b16 a[34:35], v6 offset:33792
    v_mfma_f32_32x32x16_bf16 v[144:159], a[44:47], a[16:19], v[144:159]
    ds_read_b64_tr_b16 a[36:37], v6 offset:36864
    ds_read_b64_tr_b16 a[38:39], v6 offset:37888
    ds_read_b128 a[0:3], v4 offset:0
    v_mfma_f32_32x32x16_bf16 v[160:175], a[40:43], a[20:23], v[160:175]
    ds_read_b128 a[4:7], v4 offset:4096
    ds_read_b128 a[8:11], v4 offset:8192
    v_mfma_f32_32x32x16_bf16 v[176:191], a[44:47], a[20:23], v[176:191]
    ds_read_b128 a[12:15], v4 offset:12288
    s_add_u32 m0, s58, 149504
    s_add_u32 s47, s57, 868352
    buffer_load_dwordx4 v11, s[24:27], s47 offen lds
    v_mfma_f32_32x32x16_bf16 v[192:207], a[40:43], a[24:27], v[192:207]
    s_add_u32 m0, s43, 73728
    s_add_u32 s46, s42, 974848
    buffer_load_dwordx4 v9, s[16:19], s46 offen lds
    v_mfma_f32_32x32x16_bf16 v[208:223], a[44:47], a[24:27], v[208:223]
    s_add_u32 m0, s43, 77824
    s_add_u32 s46, s42, 974848
    buffer_load_dwordx4 v9, s[20:23], s46 offen lds
    v_mfma_f32_32x32x16_bf16 v[224:239], a[40:43], a[28:31], v[224:239]
    s_add_u32 m0, s41, 50176
    s_add_u32 s46, s40, 33280
    buffer_load_dwordx4 v8, s[32:35], s46 offen sc1 lds
    v_mfma_f32_32x32x16_bf16 v[240:255], a[44:47], a[28:31], v[240:255]
    s_waitcnt lgkmcnt(0)
    v_mfma_f32_32x32x16_bf16 v[128:143], a[32:35], a[0:3], v[128:143]
    ds_read_b64_tr_b16 a[40:41], v6 offset:40960
    ds_read_b64_tr_b16 a[42:43], v6 offset:41984
    v_mfma_f32_32x32x16_bf16 v[144:159], a[36:39], a[0:3], v[144:159]
    ds_read_b64_tr_b16 a[44:45], v6 offset:45056
    ds_read_b64_tr_b16 a[46:47], v6 offset:46080
    ds_read_b128 a[16:19], v5 offset:0
    v_mfma_f32_32x32x16_bf16 v[160:175], a[32:35], a[4:7], v[160:175]
    ds_read_b128 a[20:23], v5 offset:4096
    ds_read_b128 a[24:27], v5 offset:8192
    v_mfma_f32_32x32x16_bf16 v[176:191], a[36:39], a[4:7], v[176:191]
    ds_read_b128 a[28:31], v5 offset:12288
    s_add_u32 m0, s58, 151552
    s_add_u32 s47, s57, 884736
    buffer_load_dwordx4 v11, s[24:27], s47 offen lds
    v_mfma_f32_32x32x16_bf16 v[192:207], a[32:35], a[8:11], v[192:207]
    s_add_u32 m0, s43, 81920
    s_add_u32 s46, s42, 1032192
    buffer_load_dwordx4 v9, s[16:19], s46 offen lds
    v_mfma_f32_32x32x16_bf16 v[208:223], a[36:39], a[8:11], v[208:223]
    s_add_u32 m0, s43, 86016
    s_add_u32 s46, s42, 1032192
    buffer_load_dwordx4 v9, s[20:23], s46 offen lds
    v_mfma_f32_32x32x16_bf16 v[224:239], a[32:35], a[12:15], v[224:239]
    s_add_u32 m0, s41, 51200
    s_add_u32 s46, s40, 66048
    buffer_load_dwordx4 v7, s[32:35], s46 offen sc1 lds
    v_mfma_f32_32x32x16_bf16 v[240:255], a[36:39], a[12:15], v[240:255]
    s_waitcnt lgkmcnt(0)
    v_mfma_f32_32x32x16_bf16 v[128:143], a[40:43], a[16:19], v[128:143]
    s_waitcnt vmcnt(12)
    s_barrier
    v_add_u32 v6, 0xfffe8000, v6
    v_add_u32 v2, 0xfffe8000, v2
    ds_read_b64_tr_b16 a[32:33], v6 offset:16384
    ds_read_b64_tr_b16 a[34:35], v6 offset:17408
    v_mfma_f32_32x32x16_bf16 v[144:159], a[44:47], a[16:19], v[144:159]
    ds_read_b64_tr_b16 a[36:37], v6 offset:20480
    ds_read_b64_tr_b16 a[38:39], v6 offset:21504
    ds_read_b128 a[0:3], v2 offset:0
    v_mfma_f32_32x32x16_bf16 v[160:175], a[40:43], a[20:23], v[160:175]
    ds_read_b128 a[4:7], v2 offset:4096
    ds_read_b128 a[8:11], v2 offset:8192
    v_mfma_f32_32x32x16_bf16 v[176:191], a[44:47], a[20:23], v[176:191]
    ds_read_b128 a[12:15], v2 offset:12288
    v_add_u32 v3, 0xfffe8000, v3
    v_add_u32 v4, 0xfffe8000, v4
    v_add_u32 v5, 0xfffe8000, v5
    s_add_u32 m0, s58, 153600
    s_add_u32 s47, s57, 901120
    buffer_load_dwordx4 v11, s[24:27], s47 offen lds
    v_mfma_f32_32x32x16_bf16 v[192:207], a[40:43], a[24:27], v[192:207]
    s_add_u32 m0, s43, 90112
    s_add_u32 s46, s42, 1089536
    buffer_load_dwordx4 v9, s[16:19], s46 offen lds
    v_mfma_f32_32x32x16_bf16 v[208:223], a[44:47], a[24:27], v[208:223]
    s_add_u32 m0, s43, 94208
    s_add_u32 s46, s42, 1089536
    buffer_load_dwordx4 v9, s[20:23], s46 offen lds
    v_mfma_f32_32x32x16_bf16 v[224:239], a[40:43], a[28:31], v[224:239]
    s_add_u32 m0, s41, 52224
    s_add_u32 s46, s40, 98816
    buffer_load_dwordx4 v8, s[32:35], s46 offen sc1 lds
    v_mfma_f32_32x32x16_bf16 v[240:255], a[44:47], a[28:31], v[240:255]
    s_waitcnt lgkmcnt(0)
    v_mfma_f32_32x32x16_bf16 v[128:143], a[32:35], a[0:3], v[128:143]
    ds_read_b64_tr_b16 a[40:41], v6 offset:24576
    ds_read_b64_tr_b16 a[42:43], v6 offset:25600
    v_mul_f32 v119, 0x3a000000, v118
    v_lshrrev_b32 v120, 4, v1
    v_cvt_f32_u32 v120, v120
    v_mfma_f32_32x32x16_bf16 v[144:159], a[36:39], a[0:3], v[144:159]
    ds_read_b64_tr_b16 a[44:45], v6 offset:28672
    ds_read_b64_tr_b16 a[46:47], v6 offset:29696
    ds_read_b128 a[16:19], v3 offset:0
    v_mul_f32 v120, 0x41000000, v120
    v_mul_f32 v114, v120, v119
    v_mfma_f32_32x32x16_bf16 v[160:175], a[32:35], a[4:7], v[160:175]
    ds_read_b128 a[20:23], v3 offset:4096
    ds_read_b128 a[24:27], v3 offset:8192
    v_cos_f32 v80, v114
    v_sin_f32 v88, v114
    v_mfma_f32_32x32x16_bf16 v[176:191], a[36:39], a[4:7], v[176:191]
    ds_read_b128 a[28:31], v3 offset:12288
    v_add_f32 v114, v114, v119
    v_cos_f32 v81, v114
    v_mfma_f32_32x32x16_bf16 v[192:207], a[32:35], a[8:11], v[192:207]
    s_add_u32 m0, s43, 114688
    s_add_u32 s46, s42, 1146880
    buffer_load_dwordx4 v9, s[16:19], s46 offen lds
    v_sin_f32 v89, v114
    v_add_f32 v114, v114, v119
    v_mfma_f32_32x32x16_bf16 v[208:223], a[36:39], a[8:11], v[208:223]
    s_add_u32 m0, s43, 118784
    s_add_u32 s46, s42, 1146880
    buffer_load_dwordx4 v9, s[20:23], s46 offen lds
    v_cos_f32 v82, v114
    v_sin_f32 v90, v114
    v_mfma_f32_32x32x16_bf16 v[224:239], a[32:35], a[12:15], v[224:239]
    s_add_u32 m0, s41, 98304
    s_add_u32 s46, s40, 640
    buffer_load_dwordx4 v7, s[32:35], s46 offen sc1 lds
    v_add_f32 v114, v114, v119
    v_cos_f32 v83, v114
    v_mfma_f32_32x32x16_bf16 v[240:255], a[36:39], a[12:15], v[240:255]
    v_sin_f32 v91, v114
    v_add_f32 v114, v114, v119
    s_waitcnt lgkmcnt(0)
    v_mfma_f32_32x32x16_bf16 v[128:143], a[40:43], a[16:19], v[128:143]
    ds_read_b64_tr_b16 a[32:33], v6 offset:32768
    ds_read_b64_tr_b16 a[34:35], v6 offset:33792
    v_cos_f32 v84, v114
    v_sin_f32 v92, v114
    v_add_f32 v114, v114, v119
    v_mfma_f32_32x32x16_bf16 v[144:159], a[44:47], a[16:19], v[144:159]
    ds_read_b64_tr_b16 a[36:37], v6 offset:36864
    ds_read_b64_tr_b16 a[38:39], v6 offset:37888
    ds_read_b128 a[0:3], v4 offset:0
    v_cos_f32 v85, v114
    v_sin_f32 v93, v114
    v_mfma_f32_32x32x16_bf16 v[160:175], a[40:43], a[20:23], v[160:175]
    ds_read_b128 a[4:7], v4 offset:4096
    ds_read_b128 a[8:11], v4 offset:8192
    v_add_f32 v114, v114, v119
    v_cos_f32 v86, v114
    v_mfma_f32_32x32x16_bf16 v[176:191], a[44:47], a[20:23], v[176:191]
    ds_read_b128 a[12:15], v4 offset:12288
    v_sin_f32 v94, v114
    v_add_f32 v114, v114, v119
    v_mfma_f32_32x32x16_bf16 v[192:207], a[40:43], a[24:27], v[192:207]
    s_add_u32 m0, s43, 122880
    s_add_u32 s46, s42, 1204224
    buffer_load_dwordx4 v9, s[16:19], s46 offen lds
    v_cos_f32 v87, v114
    v_sin_f32 v95, v114
    v_mfma_f32_32x32x16_bf16 v[208:223], a[44:47], a[24:27], v[208:223]
    s_add_u32 m0, s43, 126976
    s_add_u32 s46, s42, 1204224
    buffer_load_dwordx4 v9, s[20:23], s46 offen lds
    v_bfe_u32 v114, v1, 2, 2
    v_and_b32 v115, 3, v1
    v_mfma_f32_32x32x16_bf16 v[224:239], a[40:43], a[28:31], v[224:239]
    s_add_u32 m0, s41, 99328
    s_add_u32 s46, s40, 33408
    buffer_load_dwordx4 v8, s[32:35], s46 offen sc1 lds
    v_lshl_add_u32 v114, v114, 3, v115
    v_cvt_f32_u32 v118, v114
    v_mfma_f32_32x32x16_bf16 v[240:255], a[44:47], a[28:31], v[240:255]
    v_add_f32 v119, 0x0, v118
    v_mul_f32 v119, 0x3d000000, v119
    s_waitcnt lgkmcnt(0)
    v_mfma_f32_32x32x16_bf16 v[128:143], a[32:35], a[0:3], v[128:143]
    ds_read_b64_tr_b16 a[40:41], v6 offset:40960
    ds_read_b64_tr_b16 a[42:43], v6 offset:41984
    v_mul_f32 v121, v120, v119
    v_add_f32 v115, v121, v119
    v_cos_f32 v116, v121
    v_mfma_f32_32x32x16_bf16 v[144:159], a[36:39], a[0:3], v[144:159]
    ds_read_b64_tr_b16 a[44:45], v6 offset:45056
    ds_read_b64_tr_b16 a[46:47], v6 offset:46080
    ds_read_b128 a[16:19], v5 offset:0
    v_cos_f32 v117, v115
    v_sin_f32 v114, v121
    v_mfma_f32_32x32x16_bf16 v[160:175], a[32:35], a[4:7], v[160:175]
    ds_read_b128 a[20:23], v5 offset:4096
    ds_read_b128 a[24:27], v5 offset:8192
    v_add_f32 v121, v115, v119
    v_sin_f32 v115, v115
    v_mfma_f32_32x32x16_bf16 v[176:191], a[36:39], a[4:7], v[176:191]
    ds_read_b128 a[28:31], v5 offset:12288
    v_cvt_pk_bf16_f32 v116, v116, v117
    v_cvt_pk_bf16_f32 v117, -v114, -v115
    v_mfma_f32_32x32x16_bf16 v[192:207], a[32:35], a[8:11], v[192:207]
    s_add_u32 m0, s43, 131072
    s_add_u32 s46, s42, 1261568
    buffer_load_dwordx4 v9, s[16:19], s46 offen lds
    v_cvt_pk_bf16_f32 v114, v114, v115
    v_accvgpr_write_b32 a112, v116
    v_mfma_f32_32x32x16_bf16 v[208:223], a[36:39], a[8:11], v[208:223]
    s_add_u32 m0, s43, 135168
    s_add_u32 s46, s42, 1261568
    buffer_load_dwordx4 v9, s[20:23], s46 offen lds
    v_accvgpr_write_b32 a128, v117
    v_accvgpr_write_b32 a120, v114
    v_mfma_f32_32x32x16_bf16 v[224:239], a[32:35], a[12:15], v[224:239]
    s_add_u32 m0, s41, 100352
    s_add_u32 s46, s40, 66176
    buffer_load_dwordx4 v7, s[32:35], s46 offen sc1 lds
    v_add_f32 v115, v121, v119
    v_cos_f32 v116, v121
    v_mfma_f32_32x32x16_bf16 v[240:255], a[36:39], a[12:15], v[240:255]
    v_cos_f32 v117, v115
    v_sin_f32 v114, v121
    s_waitcnt lgkmcnt(0)
    v_mfma_f32_32x32x16_bf16 v[128:143], a[40:43], a[16:19], v[128:143]
    s_waitcnt vmcnt(9)
    s_barrier
    v_add_u32 v6, 0xc000, v6
    v_add_u32 v2, 0xc000, v2
    ds_read_b64_tr_b16 a[32:33], v6 offset:16384
    ds_read_b64_tr_b16 a[34:35], v6 offset:17408
    v_add_f32 v121, v115, v119
    v_sin_f32 v115, v115
    v_cvt_pk_bf16_f32 v116, v116, v117
    v_mfma_f32_32x32x16_bf16 v[144:159], a[44:47], a[16:19], v[144:159]
    ds_read_b64_tr_b16 a[36:37], v6 offset:20480
    ds_read_b64_tr_b16 a[38:39], v6 offset:21504
    ds_read_b128 a[0:3], v2 offset:0
    v_cvt_pk_bf16_f32 v117, -v114, -v115
    v_cvt_pk_bf16_f32 v114, v114, v115
    v_mfma_f32_32x32x16_bf16 v[160:175], a[40:43], a[20:23], v[160:175]
    ds_read_b128 a[4:7], v2 offset:4096
    ds_read_b128 a[8:11], v2 offset:8192
    v_accvgpr_write_b32 a113, v116
    v_accvgpr_write_b32 a129, v117
    v_mfma_f32_32x32x16_bf16 v[176:191], a[44:47], a[20:23], v[176:191]
    ds_read_b128 a[12:15], v2 offset:12288
    v_add_u32 v3, 0xc000, v3
    v_add_u32 v4, 0xc000, v4
    v_add_u32 v5, 0xc000, v5
    v_accvgpr_write_b32 a121, v114
    v_add_f32 v115, v121, v119
    v_mfma_f32_32x32x16_bf16 v[192:207], a[40:43], a[24:27], v[192:207]
    s_add_u32 m0, s43, 139264
    s_add_u32 s46, s42, 1318912
    buffer_load_dwordx4 v9, s[16:19], s46 offen lds
    v_cos_f32 v116, v121
    v_cos_f32 v117, v115
    v_mfma_f32_32x32x16_bf16 v[208:223], a[44:47], a[24:27], v[208:223]
    s_add_u32 m0, s43, 143360
    s_add_u32 s46, s42, 1318912
    buffer_load_dwordx4 v9, s[20:23], s46 offen lds
    v_sin_f32 v114, v121
    v_add_f32 v121, v115, v119
    v_mfma_f32_32x32x16_bf16 v[224:239], a[40:43], a[28:31], v[224:239]
    s_add_u32 m0, s41, 101376
    s_add_u32 s46, s40, 98944
    buffer_load_dwordx4 v8, s[32:35], s46 offen sc1 lds
    v_sin_f32 v115, v115
    v_cvt_pk_bf16_f32 v116, v116, v117
    v_mfma_f32_32x32x16_bf16 v[240:255], a[44:47], a[28:31], v[240:255]
    v_cvt_pk_bf16_f32 v117, -v114, -v115
    v_cvt_pk_bf16_f32 v114, v114, v115
L_b16:
    s_waitcnt lgkmcnt(0)
    v_mfma_f32_32x32x16_bf16 v[128:143], a[32:35], a[0:3], v[128:143]
    ds_read_b64_tr_b16 a[40:41], v6 offset:24576
    ds_read_b64_tr_b16 a[42:43], v6 offset:25600
    v_accvgpr_write_b32 a114, v116
    v_accvgpr_write_b32 a130, v117
    v_accvgpr_write_b32 a122, v114
    v_mfma_f32_32x32x16_bf16 v[144:159], a[36:39], a[0:3], v[144:159]
    ds_read_b64_tr_b16 a[44:45], v6 offset:28672
    ds_read_b64_tr_b16 a[46:47], v6 offset:29696
    ds_read_b128 a[16:19], v3 offset:0
    v_add_f32 v115, v121, v119
    v_cos_f32 v116, v121
    v_mfma_f32_32x32x16_bf16 v[160:175], a[32:35], a[4:7], v[160:175]
    ds_read_b128 a[20:23], v3 offset:4096
    ds_read_b128 a[24:27], v3 offset:8192
    v_cos_f32 v117, v115
    v_sin_f32 v114, v121
    v_mfma_f32_32x32x16_bf16 v[176:191], a[36:39], a[4:7], v[176:191]
    ds_read_b128 a[28:31], v3 offset:12288
    ds_read_b64_tr_b16 a[136:137], v20 offset:16384
    ds_read_b64_tr_b16 a[138:139], v20 offset:16896
    ds_read_b64_tr_b16 a[140:141], v21 offset:16384
    ds_read_b64_tr_b16 a[142:143], v21 offset:16896
    ds_read_b64_tr_b16 a[144:145], v20 offset:18432
    ds_read_b64_tr_b16 a[146:147], v20 offset:18944
    ds_read_b64_tr_b16 a[148:149], v21 offset:18432
    ds_read_b64_tr_b16 a[150:151], v21 offset:18944
    v_lshlrev_b32 v15, 2, v1
    s_lshl_b32 s51, s36, 8
    s_add_u32 s51, s51, 0x1109000
    buffer_load_dword v126, v15, s[32:35], s51 offen sc1
    v_add_f32 v121, v115, v119
    v_sin_f32 v115, v115
    v_mfma_f32_32x32x16_bf16 v[192:207], a[32:35], a[8:11], v[192:207]
    s_add_u32 m0, s43, 16384
    s_add_u32 s46, s42, 1376256
    buffer_load_dwordx4 v9, s[16:19], s46 offen lds
    v_cvt_pk_bf16_f32 v116, v116, v117
    v_cvt_pk_bf16_f32 v117, -v114, -v115
    v_mfma_f32_32x32x16_bf16 v[208:223], a[36:39], a[8:11], v[208:223]
    s_add_u32 m0, s43, 20480
    s_add_u32 s46, s42, 1376256
    buffer_load_dwordx4 v9, s[20:23], s46 offen lds
    v_cvt_pk_bf16_f32 v114, v114, v115
    v_accvgpr_write_b32 a115, v116
    v_mfma_f32_32x32x16_bf16 v[224:239], a[32:35], a[12:15], v[224:239]
    s_add_u32 m0, s41, 0
    s_add_u32 s46, s40, 768
    buffer_load_dwordx4 v7, s[32:35], s46 offen sc1 lds
    v_accvgpr_write_b32 a131, v117
    v_accvgpr_write_b32 a123, v114
    v_mfma_f32_32x32x16_bf16 v[240:255], a[36:39], a[12:15], v[240:255]
    v_add_f32 v119, 0x40800000, v118
    v_mul_f32 v119, 0x3d000000, v119
    s_waitcnt lgkmcnt(0)
    v_mfma_f32_32x32x16_bf16 v[128:143], a[40:43], a[16:19], v[128:143]
    ds_read_b64_tr_b16 a[32:33], v6 offset:32768
    ds_read_b64_tr_b16 a[34:35], v6 offset:33792
    v_mul_f32 v121, v120, v119
    v_add_f32 v115, v121, v119
    v_cos_f32 v116, v121
    v_mfma_f32_32x32x16_bf16 v[144:159], a[44:47], a[16:19], v[144:159]
    ds_read_b64_tr_b16 a[36:37], v6 offset:36864
    ds_read_b64_tr_b16 a[38:39], v6 offset:37888
    ds_read_b128 a[0:3], v4 offset:0
    v_cos_f32 v117, v115
    v_sin_f32 v114, v121
    v_mfma_f32_32x32x16_bf16 v[160:175], a[40:43], a[20:23], v[160:175]
    ds_read_b128 a[4:7], v4 offset:4096
    ds_read_b128 a[8:11], v4 offset:8192
    v_add_f32 v121, v115, v119
    v_sin_f32 v115, v115
    v_mfma_f32_32x32x16_bf16 v[176:191], a[44:47], a[20:23], v[176:191]
    ds_read_b128 a[12:15], v4 offset:12288
    ds_read_b64_tr_b16 a[152:153], v20 offset:20480
    ds_read_b64_tr_b16 a[154:155], v20 offset:20992
    ds_read_b64_tr_b16 a[156:157], v21 offset:20480
    ds_read_b64_tr_b16 a[158:159], v21 offset:20992
    ds_read_b64_tr_b16 a[160:161], v20 offset:22528
    ds_read_b64_tr_b16 a[162:163], v20 offset:23040
    ds_read_b64_tr_b16 a[164:165], v21 offset:22528
    ds_read_b64_tr_b16 a[166:167], v21 offset:23040
    v_lshrrev_b32 v12, 4, v1
    v_xor_b32 v12, v12, v1
    v_and_b32 v12, 3, v12
    v_lshlrev_b32 v12, 4, v12
    v_lshrrev_b32 v13, 2, v1
    v_and_b32 v13, 1, v13
    v_lshl_add_u32 v12, v13, 6, v12
    v_cvt_pk_bf16_f32 v116, v116, v117
    v_cvt_pk_bf16_f32 v117, -v114, -v115
    v_mfma_f32_32x32x16_bf16 v[192:207], a[40:43], a[24:27], v[192:207]
    s_add_u32 m0, s43, 24576
    s_add_u32 s46, s42, 1433600
    buffer_load_dwordx4 v9, s[16:19], s46 offen lds
    v_lshrrev_b32 v13, 3, v1
    v_lshl_add_u32 v13, v13, 11, v12
    v_lshrrev_b32 v12, 5, v1
    v_lshlrev_b32 v127, 11, v12
    v_lshlrev_b32 v123, 9, v12
    v_bfe_u32 v12, v1, 2, 2
    v_lshl_add_u32 v127, v12, 9, v127
    v_cvt_pk_bf16_f32 v114, v114, v115
    v_accvgpr_write_b32 a116, v116
    v_mfma_f32_32x32x16_bf16 v[208:223], a[44:47], a[24:27], v[208:223]
    s_add_u32 m0, s43, 28672
    s_add_u32 s46, s42, 1433600
    buffer_load_dwordx4 v9, s[20:23], s46 offen lds
    v_and_b32 v12, 3, v1
    v_lshl_add_u32 v127, v12, 6, v127
    v_bfe_u32 v12, v1, 4, 1
    v_lshl_add_u32 v123, v12, 12, v123
    v_bfe_u32 v14, v1, 2, 1
    v_lshl_add_u32 v12, v14, 1, v12
    v_lshl_add_u32 v127, v12, 4, v127
    v_accvgpr_write_b32 a132, v117
    v_accvgpr_write_b32 a124, v114
    v_mfma_f32_32x32x16_bf16 v[224:239], a[40:43], a[28:31], v[224:239]
    s_add_u32 m0, s41, 1024
    s_add_u32 s46, s40, 33536
    buffer_load_dwordx4 v8, s[32:35], s46 offen sc1 lds
    v_and_b32 v12, 15, v1
    v_lshl_add_u32 v123, v12, 4, v123
    v_lshlrev_b32 v122, 6, v12
    v_lshrrev_b32 v14, 2, v12
    v_add_f32 v115, v121, v119
    v_cos_f32 v116, v121
    v_mfma_f32_32x32x16_bf16 v[240:255], a[44:47], a[28:31], v[240:255]
    v_cos_f32 v117, v115
    v_sin_f32 v114, v121
    s_waitcnt lgkmcnt(0)
    v_mfma_f32_32x32x16_bf16 v[128:143], a[32:35], a[0:3], v[128:143]
    ds_read_b64_tr_b16 a[40:41], v6 offset:40960
    ds_read_b64_tr_b16 a[42:43], v6 offset:41984
    v_add_f32 v121, v115, v119
    v_sin_f32 v115, v115
    v_cvt_pk_bf16_f32 v116, v116, v117
    v_mfma_f32_32x32x16_bf16 v[144:159], a[36:39], a[0:3], v[144:159]
    ds_read_b64_tr_b16 a[44:45], v6 offset:45056
    ds_read_b64_tr_b16 a[46:47], v6 offset:46080
    ds_read_b128 a[16:19], v5 offset:0
    v_cvt_pk_bf16_f32 v117, -v114, -v115
    v_cvt_pk_bf16_f32 v114, v114, v115
    v_mfma_f32_32x32x16_bf16 v[160:175], a[32:35], a[4:7], v[160:175]
    ds_read_b128 a[20:23], v5 offset:4096
    ds_read_b128 a[24:27], v5 offset:8192
    v_accvgpr_write_b32 a117, v116
    v_accvgpr_write_b32 a133, v117
    v_mfma_f32_32x32x16_bf16 v[176:191], a[36:39], a[4:7], v[176:191]
    ds_read_b128 a[28:31], v5 offset:12288
    s_cmp_lg_u32 s36, 0
    s_cbranch_scc1 L_ct2
    s_getpc_b64 s[48:49]
L_pc2:
    s_add_u32 s48, s48, L_b24-L_pc2
    s_addc_u32 s49, s49, 0
    s_lshr_b32 s47, s2, 3
    s_mul_i32 s47, s47, 256
    v_lshl_add_u32 v124, v0, 7, s47
    v_min_u32 v124, L_noB-L_b24-4, v124
    v_mov_b32 v125, 0
    v_lshl_add_u64 v[124:125], v[124:125], 0, s[48:49]
    s_mov_b64 exec, 3
    global_load_dword a252, v[124:125], off
    s_mov_b64 exec, -1
L_ct2:
    v_accvgpr_write_b32 a125, v114
    v_add_f32 v115, v121, v119
    v_mfma_f32_32x32x16_bf16 v[192:207], a[32:35], a[8:11], v[192:207]
    s_add_u32 m0, s43, 32768
    s_add_u32 s46, s42, 1490944
    buffer_load_dwordx4 v9, s[16:19], s46 offen lds
    v_xor_b32 v14, 2, v14
    v_lshl_add_u32 v14, v14, 4, v122
    v_lshrrev_b32 v12, 4, v1
    v_lshl_add_u32 v14, v12, 12, v14
    v_bfe_u32 v23, v1, 1, 2
    v_xor_b32 v23, v23, v12
    v_lshl_add_u32 v122, v23, 4, v122
    v_cos_f32 v116, v121
    v_cos_f32 v117, v115
    v_mfma_f32_32x32x16_bf16 v[208:223], a[36:39], a[8:11], v[208:223]
    s_add_u32 m0, s43, 36864
    s_add_u32 s46, s42, 1490944
    buffer_load_dwordx4 v9, s[20:23], s46 offen lds
    s_lshl_b32 s96, s36, 10
    s_add_u32 s96, s96, 147456
    v_add_u32 v122, s96, v122
    v_add_u32 v14, s96, v14
    v_add_u32 v127, 147456, v127
    v_add_u32 v123, 147456, v123
    v_bfe_u32 v23, v1, 3, 1
    v_sin_f32 v114, v121
    v_add_f32 v121, v115, v119
    v_mfma_f32_32x32x16_bf16 v[224:239], a[32:35], a[12:15], v[224:239]
    s_add_u32 m0, s41, 2048
    s_add_u32 s46, s40, 66304
    buffer_load_dwordx4 v7, s[32:35], s46 offen sc1 lds
    v_lshlrev_b32 v23, 4, v23
    v_xor_b32 v123, v123, v23
    v_xor_b32 v23, 32, v123
    s_lshr_b32 s96, s45, 8
    s_mul_i32 s96, s96, 262272
    s_and_b32 s97, s45, 255
    s_lshl_b32 s97, s97, 3
    v_sin_f32 v115, v115
    v_cvt_pk_bf16_f32 v116, v116, v117
    v_mfma_f32_32x32x16_bf16 v[240:255], a[36:39], a[12:15], v[240:255]
    s_add_u32 s96, s96, s97
    s_lshl_b32 s97, s36, 16
    s_add_u32 s96, s96, s97
    s_add_u32 s96, s96, 0xa00000
    v_cvt_pk_bf16_f32 v117, -v114, -v115
    v_cvt_pk_bf16_f32 v114, v114, v115
    s_waitcnt lgkmcnt(0)
    v_mfma_f32_32x32x16_bf16 v[128:143], a[40:43], a[16:19], v[128:143]
    s_waitcnt vmcnt(9)
    v_cmp_ne_u32 vcc, s37, v126
    s_nop 1
    s_cbranch_vccnz L_s2a_spin
L_s2a_ok:
    s_barrier
    v_add_u32 v6, 0xc000, v6
    v_add_u32 v2, 0xc000, v2
    ds_read_b64_tr_b16 a[32:33], v6 offset:16384
    ds_read_b64_tr_b16 a[34:35], v6 offset:17408
    v_accvgpr_write_b32 a118, v116
    v_accvgpr_write_b32 a134, v117
    v_mfma_f32_32x32x16_bf16 v[144:159], a[44:47], a[16:19], v[144:159]
    ds_read_b64_tr_b16 a[36:37], v6 offset:20480
    ds_read_b64_tr_b16 a[38:39], v6 offset:21504
    ds_read_b128 a[0:3], v2 offset:0
    v_accvgpr_write_b32 a126, v114
    v_add_f32 v115, v121, v119
    v_mfma_f32_32x32x16_bf16 v[160:175], a[40:43], a[20:23], v[160:175]
    ds_read_b128 a[4:7], v2 offset:4096
    ds_read_b128 a[8:11], v2 offset:8192
    v_cos_f32 v116, v121
    v_cos_f32 v117, v115
    v_mfma_f32_32x32x16_bf16 v[176:191], a[44:47], a[20:23], v[176:191]
    ds_read_b128 a[12:15], v2 offset:12288
    v_add_u32 v3, 0xc000, v3
    v_add_u32 v4, 0xc000, v4
    v_add_u32 v5, 0xc000, v5
    v_sin_f32 v114, v121
    v_add_f32 v121, v115, v119
    v_mfma_f32_32x32x16_bf16 v[192:207], a[40:43], a[24:27], v[192:207]
    s_add_u32 m0, s43, 40960
    s_add_u32 s46, s42, 1548288
    buffer_load_dwordx4 v9, s[16:19], s46 offen lds
    v_sin_f32 v115, v115
    v_cvt_pk_bf16_f32 v116, v116, v117
    v_mfma_f32_32x32x16_bf16 v[208:223], a[44:47], a[24:27], v[208:223]
    s_add_u32 m0, s43, 45056
    s_add_u32 s46, s42, 1548288
    buffer_load_dwordx4 v9, s[20:23], s46 offen lds
    v_cvt_pk_bf16_f32 v117, -v114, -v115
    v_cvt_pk_bf16_f32 v114, v114, v115
    v_mfma_f32_32x32x16_bf16 v[224:239], a[40:43], a[28:31], v[224:239]
    s_add_u32 m0, s41, 3072
    s_add_u32 s46, s40, 99072
    buffer_load_dwordx4 v8, s[32:35], s46 offen sc1 lds
    v_accvgpr_write_b32 a119, v116
    v_accvgpr_write_b32 a135, v117
    v_mfma_f32_32x32x16_bf16 v[240:255], a[44:47], a[28:31], v[240:255]
    v_accvgpr_write_b32 a127, v114
    s_waitcnt lgkmcnt(0)
    v_mfma_f32_32x32x16_bf16 v[128:143], a[32:35], a[0:3], v[128:143]
    ds_read_b64_tr_b16 a[40:41], v6 offset:24576
    ds_read_b64_tr_b16 a[42:43], v6 offset:25600
    v_mfma_f32_32x32x16_bf16 v[144:159], a[36:39], a[0:3], v[144:159]
    ds_read_b64_tr_b16 a[44:45], v6 offset:28672
    ds_read_b64_tr_b16 a[46:47], v6 offset:29696
    ds_read_b128 a[16:19], v3 offset:0
    v_mfma_f32_32x32x16_bf16 v[160:175], a[32:35], a[4:7], v[160:175]
    ds_read_b128 a[20:23], v3 offset:4096
    ds_read_b128 a[24:27], v3 offset:8192
    v_mfma_f32_32x32x16_bf16 v[176:191], a[36:39], a[4:7], v[176:191]
    ds_read_b128 a[28:31], v3 offset:12288
    s_lshl_b32 m0, s36, 12
    s_add_u32 m0, m0, 147456
    s_nop 0
    buffer_load_dwordx4 v13, s[32:35], s96 offen sc1 lds
    s_add_u32 s96, s96, 16384
    s_lshl_b32 m0, s36, 12
    s_add_u32 m0, m0, 148480
    s_nop 0
    buffer_load_dwordx4 v13, s[32:35], s96 offen sc1 lds
    s_add_u32 s96, s96, 16384
    v_mfma_f32_32x32x16_bf16 v[192:207], a[32:35], a[8:11], v[192:207]
    s_add_u32 m0, s43, 65536
    s_add_u32 s46, s42, 1605632
    buffer_load_dwordx4 v9, s[16:19], s46 offen lds
    v_mfma_f32_32x32x16_bf16 v[208:223], a[36:39], a[8:11], v[208:223]
    s_add_u32 m0, s43, 69632
    s_add_u32 s46, s42, 1605632
    buffer_load_dwordx4 v9, s[20:23], s46 offen lds
    v_mfma_f32_32x32x16_bf16 v[224:239], a[32:35], a[12:15], v[224:239]
    s_add_u32 m0, s41, 49152
    s_add_u32 s46, s40, 896
    buffer_load_dwordx4 v7, s[32:35], s46 offen sc1 lds
    v_mfma_f32_32x32x16_bf16 v[240:255], a[36:39], a[12:15], v[240:255]
    s_waitcnt lgkmcnt(0)
    v_mfma_f32_32x32x16_bf16 v[128:143], a[40:43], a[16:19], v[128:143]
    ds_read_b64_tr_b16 a[32:33], v6 offset:32768
    ds_read_b64_tr_b16 a[34:35], v6 offset:33792
    v_mfma_f32_32x32x16_bf16 v[144:159], a[44:47], a[16:19], v[144:159]
    ds_read_b64_tr_b16 a[36:37], v6 offset:36864
    ds_read_b64_tr_b16 a[38:39], v6 offset:37888
    ds_read_b128 a[0:3], v4 offset:0
    v_mfma_f32_32x32x16_bf16 v[160:175], a[40:43], a[20:23], v[160:175]
    ds_read_b128 a[4:7], v4 offset:4096
    ds_read_b128 a[8:11], v4 offset:8192
    v_mfma_f32_32x32x16_bf16 v[176:191], a[44:47], a[20:23], v[176:191]
    ds_read_b128 a[12:15], v4 offset:12288
    s_lshl_b32 m0, s36, 12
    s_add_u32 m0, m0, 149504
    s_nop 0
    buffer_load_dwordx4 v13, s[32:35], s96 offen sc1 lds
    s_add_u32 s96, s96, 16384
    s_lshl_b32 m0, s36, 12
    s_add_u32 m0, m0, 150528
    s_nop 0
    buffer_load_dwordx4 v13, s[32:35], s96 offen sc1 lds
    v_mfma_f32_32x32x16_bf16 v[192:207], a[40:43], a[24:27], v[192:207]
    s_add_u32 m0, s43, 73728
    s_add_u32 s46, s42, 1662976
    buffer_load_dwordx4 v9, s[16:19], s46 offen lds
    v_mfma_f32_32x32x16_bf16 v[208:223], a[44:47], a[24:27], v[208:223]
    s_add_u32 m0, s43, 77824
    s_add_u32 s46, s42, 1662976
    buffer_load_dwordx4 v9, s[20:23], s46 offen lds
    v_mfma_f32_32x32x16_bf16 v[224:239], a[40:43], a[28:31], v[224:239]
    s_add_u32 m0, s41, 50176
    s_add_u32 s46, s40, 33664
    buffer_load_dwordx4 v8, s[32:35], s46 offen sc1 lds
    v_mfma_f32_32x32x16_bf16 v[240:255], a[44:47], a[28:31], v[240:255]
    s_waitcnt lgkmcnt(0)
    v_mfma_f32_32x32x16_bf16 v[128:143], a[32:35], a[0:3], v[128:143]
    ds_read_b64_tr_b16 a[40:41], v6 offset:40960
    ds_read_b64_tr_b16 a[42:43], v6 offset:41984
    v_mfma_f32_32x32x16_bf16 v[144:159], a[36:39], a[0:3], v[144:159]
    ds_read_b64_tr_b16 a[44:45], v6 offset:45056
    ds_read_b64_tr_b16 a[46:47], v6 offset:46080
    ds_read_b128 a[16:19], v5 offset:0
    v_mfma_f32_32x32x16_bf16 v[160:175], a[32:35], a[4:7], v[160:175]
    ds_read_b128 a[20:23], v5 offset:4096
    ds_read_b128 a[24:27], v5 offset:8192
    v_mfma_f32_32x32x16_bf16 v[176:191], a[36:39], a[4:7], v[176:191]
    ds_read_b128 a[28:31], v5 offset:12288
    v_mfma_f32_32x32x16_bf16 v[192:207], a[32:35], a[8:11], v[192:207]
    s_add_u32 m0, s43, 81920
    s_add_u32 s46, s42, 1720320
    buffer_load_dwordx4 v9, s[16:19], s46 offen lds
    v_mfma_f32_32x32x16_bf16 v[208:223], a[36:39], a[8:11], v[208:223]
    s_add_u32 m0, s43, 86016
    s_add_u32 s46, s42, 1720320
    buffer_load_dwordx4 v9, s[20:23], s46 offen lds
    v_mfma_f32_32x32x16_bf16 v[224:239], a[32:35], a[12:15], v[224:239]
    s_add_u32 m0, s41, 51200
    s_add_u32 s46, s40, 66432
    buffer_load_dwordx4 v7, s[32:35], s46 offen sc1 lds
    v_mfma_f32_32x32x16_bf16 v[240:255], a[36:39], a[12:15], v[240:255]
    s_waitcnt lgkmcnt(0)
    v_mfma_f32_32x32x16_bf16 v[128:143], a[40:43], a[16:19], v[128:143]
    s_waitcnt vmcnt(13)
    s_barrier
    v_add_u32 v6, 0xfffe8000, v6
    v_add_u32 v2, 0xfffe8000, v2
    ds_read_b64_tr_b16 a[32:33], v6 offset:16384
    ds_read_b64_tr_b16 a[34:35], v6 offset:17408
    v_mfma_f32_32x32x16_bf16 v[144:159], a[44:47], a[16:19], v[144:159]
    ds_read_b64_tr_b16 a[36:37], v6 offset:20480
    ds_read_b64_tr_b16 a[38:39], v6 offset:21504
    ds_read_b128 a[0:3], v2 offset:0
    v_mfma_f32_32x32x16_bf16 v[160:175], a[40:43], a[20:23], v[160:175]
    ds_read_b128 a[4:7], v2 offset:4096
    ds_read_b128 a[8:11], v2 offset:8192
    v_mfma_f32_32x32x16_bf16 v[176:191], a[44:47], a[20:23], v[176:191]
    ds_read_b128 a[12:15], v2 offset:12288
    v_add_u32 v3, 0xfffe8000, v3
    v_add_u32 v4, 0xfffe8000, v4
    v_add_u32 v5, 0xfffe8000, v5
    v_mfma_f32_32x32x16_bf16 v[192:207], a[40:43], a[24:27], v[192:207]
    s_add_u32 m0, s43, 90112
    s_add_u32 s46, s42, 1777664
    buffer_load_dwordx4 v9, s[16:19], s46 offen lds
    v_mfma_f32_32x32x16_bf16 v[208:223], a[44:47], a[24:27], v[208:223]
    s_add_u32 m0, s43, 94208
    s_add_u32 s46, s42, 1777664
    buffer_load_dwordx4 v9, s[20:23], s46 offen lds
    v_mfma_f32_32x32x16_bf16 v[224:239], a[40:43], a[28:31], v[224:239]
    s_add_u32 m0, s41, 52224
    s_add_u32 s46, s40, 99200
    buffer_load_dwordx4 v8, s[32:35], s46 offen sc1 lds
    v_mfma_f32_32x32x16_bf16 v[240:255], a[44:47], a[28:31], v[240:255]
L_b24:
    s_waitcnt lgkmcnt(0)
    v_mfma_f32_32x32x16_bf16 v[128:143], a[32:35], a[0:3], v[128:143]
    ds_read_b64_tr_b16 a[40:41], v6 offset:24576
    ds_read_b64_tr_b16 a[42:43], v6 offset:25600
    v_mfma_f32_32x32x16_bf16 v[144:159], a[36:39], a[0:3], v[144:159]
    ds_read_b64_tr_b16 a[44:45], v6 offset:28672
    ds_read_b64_tr_b16 a[46:47], v6 offset:29696
    ds_read_b128 a[16:19], v3 offset:0
    v_mfma_f32_32x32x16_bf16 v[160:175], a[32:35], a[4:7], v[160:175]
    ds_read_b128 a[20:23], v3 offset:4096
    ds_read_b128 a[24:27], v3 offset:8192
    v_mfma_f32_32x32x16_bf16 v[176:191], a[36:39], a[4:7], v[176:191]
    ds_read_b128 a[28:31], v3 offset:12288
    s_add_u32 m0, s58, 98304
    s_add_u32 s47, s57, 0
    buffer_load_dwordx4 v11, s[24:27], s47 offen lds
    v_mfma_f32_32x32x16_bf16 v[192:207], a[32:35], a[8:11], v[192:207]
    v_mfma_f32_32x32x16_bf16 v[208:223], a[36:39], a[8:11], v[208:223]
    s_add_u32 m0, s58, 100352
    s_add_u32 s47, s57, 16384
    buffer_load_dwordx4 v11, s[24:27], s47 offen lds
    v_mfma_f32_32x32x16_bf16 v[224:239], a[32:35], a[12:15], v[224:239]
    v_mfma_f32_32x32x16_bf16 v[240:255], a[36:39], a[12:15], v[240:255]
    s_waitcnt lgkmcnt(0)
    v_mfma_f32_32x32x16_bf16 v[128:143], a[40:43], a[16:19], v[128:143]
    ds_read_b64_tr_b16 a[32:33], v6 offset:32768
    ds_read_b64_tr_b16 a[34:35], v6 offset:33792
    v_mfma_f32_32x32x16_bf16 v[144:159], a[44:47], a[16:19], v[144:159]
    ds_read_b64_tr_b16 a[36:37], v6 offset:36864
    ds_read_b64_tr_b16 a[38:39], v6 offset:37888
    ds_read_b128 a[0:3], v4 offset:0
    v_mfma_f32_32x32x16_bf16 v[160:175], a[40:43], a[20:23], v[160:175]
    ds_read_b128 a[4:7], v4 offset:4096
    ds_read_b128 a[8:11], v4 offset:8192
    v_mfma_f32_32x32x16_bf16 v[176:191], a[44:47], a[20:23], v[176:191]
    ds_read_b128 a[12:15], v4 offset:12288
    s_add_u32 m0, s58, 102400
    s_add_u32 s47, s57, 32768
    buffer_load_dwordx4 v11, s[24:27], s47 offen lds
    v_mfma_f32_32x32x16_bf16 v[192:207], a[40:43], a[24:27], v[192:207]
    v_mfma_f32_32x32x16_bf16 v[208:223], a[44:47], a[24:27], v[208:223]
    s_add_u32 m0, s58, 104448
    s_add_u32 s47, s57, 49152
    buffer_load_dwordx4 v11, s[24:27], s47 offen lds
    v_mfma_f32_32x32x16_bf16 v[224:239], a[40:43], a[28:31], v[224:239]
    v_mfma_f32_32x32x16_bf16 v[240:255], a[44:47], a[28:31], v[240:255]
    s_waitcnt lgkmcnt(0)
    v_mfma_f32_32x32x16_bf16 v[128:143], a[32:35], a[0:3], v[128:143]
    ds_read_b64_tr_b16 a[40:41], v6 offset:40960
    ds_read_b64_tr_b16 a[42:43], v6 offset:41984
    v_mfma_f32_32x32x16_bf16 v[144:159], a[36:39], a[0:3], v[144:159]
    ds_read_b64_tr_b16 a[44:45], v6 offset:45056
    ds_read_b64_tr_b16 a[46:47], v6 offset:46080
    ds_read_b128 a[16:19], v5 offset:0
    v_mfma_f32_32x32x16_bf16 v[160:175], a[32:35], a[4:7], v[160:175]
    ds_read_b128 a[20:23], v5 offset:4096
    ds_read_b128 a[24:27], v5 offset:8192
    v_mfma_f32_32x32x16_bf16 v[176:191], a[36:39], a[4:7], v[176:191]
    ds_read_b128 a[28:31], v5 offset:12288
    s_cmp_lg_u32 s36, 0
    s_cbranch_scc1 L_ct3
    s_getpc_b64 s[48:49]
L_pc3:
    s_add_u32 s48, s48, L_C-L_pc3
    s_addc_u32 s49, s49, 0
    s_lshr_b32 s47, s2, 3
    s_mul_i32 s47, s47, 384
    v_lshl_add_u32 v124, v0, 7, s47
    v_min_u32 v124, L_code_end-L_C-4, v124
    v_mov_b32 v125, 0
    v_lshl_add_u64 v[124:125], v[124:125], 0, s[48:49]
    s_mov_b64 exec, 7
    global_load_dword a252, v[124:125], off
    s_mov_b64 exec, -1
L_ct3:
    v_mfma_f32_32x32x16_bf16 v[192:207], a[32:35], a[8:11], v[192:207]
    s_add_u32 m0, s58, 114688
    s_add_u32 s47, s57, 65536
    buffer_load_dwordx4 v11, s[24:27], s47 offen lds
    v_mfma_f32_32x32x16_bf16 v[208:223], a[36:39], a[8:11], v[208:223]
    s_add_u32 m0, s58, 116736
    s_add_u32 s47, s57, 81920
    buffer_load_dwordx4 v11, s[24:27], s47 offen lds
    v_mfma_f32_32x32x16_bf16 v[224:239], a[32:35], a[12:15], v[224:239]
    s_add_u32 m0, s58, 118784
    s_add_u32 s47, s57, 98304
    buffer_load_dwordx4 v11, s[24:27], s47 offen lds
    v_mfma_f32_32x32x16_bf16 v[240:255], a[36:39], a[12:15], v[240:255]
    s_waitcnt lgkmcnt(0)
    v_mfma_f32_32x32x16_bf16 v[128:143], a[40:43], a[16:19], v[128:143]
    s_waitcnt vmcnt(7)
    s_barrier
    v_add_u32 v6, 0xc000, v6
    v_add_u32 v2, 0xc000, v2
    ds_read_b64_tr_b16 a[32:33], v6 offset:16384
    ds_read_b64_tr_b16 a[34:35], v6 offset:17408
    v_mfma_f32_32x32x16_bf16 v[144:159], a[44:47], a[16:19], v[144:159]
    ds_read_b64_tr_b16 a[36:37], v6 offset:20480
    ds_read_b64_tr_b16 a[38:39], v6 offset:21504
    ds_read_b128 a[0:3], v2 offset:0
    v_mfma_f32_32x32x16_bf16 v[160:175], a[40:43], a[20:23], v[160:175]
    ds_read_b128 a[4:7], v2 offset:4096
    ds_read_b128 a[8:11], v2 offset:8192
    v_mfma_f32_32x32x16_bf16 v[176:191], a[44:47], a[20:23], v[176:191]
    ds_read_b128 a[12:15], v2 offset:12288
    v_add_u32 v3, 0xc000, v3
    v_add_u32 v4, 0xc000, v4
    v_add_u32 v5, 0xc000, v5
    s_add_u32 m0, s58, 120832
    s_add_u32 s47, s57, 114688
    buffer_load_dwordx4 v11, s[24:27], s47 offen lds
    v_mfma_f32_32x32x16_bf16 v[192:207], a[40:43], a[24:27], v[192:207]
    s_add_u32 m0, s58, 131072
    s_add_u32 s47, s57, 131072
    buffer_load_dwordx4 v11, s[24:27], s47 offen lds
    v_mfma_f32_32x32x16_bf16 v[208:223], a[44:47], a[24:27], v[208:223]
    v_mfma_f32_32x32x16_bf16 v[224:239], a[40:43], a[28:31], v[224:239]
    s_add_u32 m0, s58, 133120
    s_add_u32 s47, s57, 147456
    buffer_load_dwordx4 v11, s[24:27], s47 offen lds
    v_mfma_f32_32x32x16_bf16 v[240:255], a[44:47], a[28:31], v[240:255]
    s_waitcnt lgkmcnt(0)
    v_mfma_f32_32x32x16_bf16 v[128:143], a[32:35], a[0:3], v[128:143]
    ds_read_b64_tr_b16 a[40:41], v6 offset:24576
    ds_read_b64_tr_b16 a[42:43], v6 offset:25600
    v_mfma_f32_32x32x16_bf16 v[144:159], a[36:39], a[0:3], v[144:159]
    ds_read_b64_tr_b16 a[44:45], v6 offset:28672
    ds_read_b64_tr_b16 a[46:47], v6 offset:29696
    ds_read_b128 a[16:19], v3 offset:0
    v_mfma_f32_32x32x16_bf16 v[160:175], a[32:35], a[4:7], v[160:175]
    ds_read_b128 a[20:23], v3 offset:4096
    ds_read_b128 a[24:27], v3 offset:8192
    v_mfma_f32_32x32x16_bf16 v[176:191], a[36:39], a[4:7], v[176:191]
    ds_read_b128 a[28:31], v3 offset:12288
    s_add_u32 m0, s58, 135168
    s_add_u32 s47, s57, 163840
    buffer_load_dwordx4 v11, s[24:27], s47 offen lds
    v_mfma_f32_32x32x16_bf16 v[192:207], a[32:35], a[8:11], v[192:207]
    s_add_u32 m0, s58, 137216
    s_add_u32 s47, s57, 180224
    buffer_load_dwordx4 v11, s[24:27], s47 offen lds
    v_mfma_f32_32x32x16_bf16 v[208:223], a[36:39], a[8:11], v[208:223]
    v_mfma_f32_32x32x16_bf16 v[224:239], a[32:35], a[12:15], v[224:239]
    s_add_u32 m0, s58, 0
    s_add_u32 s47, s57, 196608
    buffer_load_dwordx4 v11, s[24:27], s47 offen lds
    v_mfma_f32_32x32x16_bf16 v[240:255], a[36:39], a[12:15], v[240:255]
    s_waitcnt lgkmcnt(0)
    v_mfma_f32_32x32x16_bf16 v[128:143], a[40:43], a[16:19], v[128:143]
    ds_read_b64_tr_b16 a[32:33], v6 offset:32768
    ds_read_b64_tr_b16 a[34:35], v6 offset:33792
    v_mfma_f32_32x32x16_bf16 v[144:159], a[44:47], a[16:19], v[144:159]
    ds_read_b64_tr_b16 a[36:37], v6 offset:36864
    ds_read_b64_tr_b16 a[38:39], v6 offset:37888
    ds_read_b128 a[0:3], v4 offset:0
    v_mfma_f32_32x32x16_bf16 v[160:175], a[40:43], a[20:23], v[160:175]
    ds_read_b128 a[4:7], v4 offset:4096
    ds_read_b128 a[8:11], v4 offset:8192
    v_mfma_f32_32x32x16_bf16 v[176:191], a[44:47], a[20:23], v[176:191]
    ds_read_b128 a[12:15], v4 offset:12288
    s_add_u32 m0, s58, 2048
    s_add_u32 s47, s57, 212992
    buffer_load_dwordx4 v11, s[24:27], s47 offen lds
    v_mfma_f32_32x32x16_bf16 v[192:207], a[40:43], a[24:27], v[192:207]
    s_add_u32 m0, s58, 4096
    s_add_u32 s47, s57, 229376
    buffer_load_dwordx4 v11, s[24:27], s47 offen lds
    v_mfma_f32_32x32x16_bf16 v[208:223], a[44:47], a[24:27], v[208:223]
    v_mfma_f32_32x32x16_bf16 v[224:239], a[40:43], a[28:31], v[224:239]
    s_add_u32 m0, s58, 6144
    s_add_u32 s47, s57, 245760
    buffer_load_dwordx4 v11, s[24:27], s47 offen lds
    v_mfma_f32_32x32x16_bf16 v[240:255], a[44:47], a[28:31], v[240:255]
    s_waitcnt lgkmcnt(0)
    v_mfma_f32_32x32x16_bf16 v[128:143], a[32:35], a[0:3], v[128:143]
    ds_read_b64_tr_b16 a[40:41], v6 offset:40960
    ds_read_b64_tr_b16 a[42:43], v6 offset:41984
    v_mfma_f32_32x32x16_bf16 v[144:159], a[36:39], a[0:3], v[144:159]
    ds_read_b64_tr_b16 a[44:45], v6 offset:45056
    ds_read_b64_tr_b16 a[46:47], v6 offset:46080
    ds_read_b128 a[16:19], v5 offset:0
    v_mfma_f32_32x32x16_bf16 v[160:175], a[32:35], a[4:7], v[160:175]
    ds_read_b128 a[20:23], v5 offset:4096
    ds_read_b128 a[24:27], v5 offset:8192
    v_mfma_f32_32x32x16_bf16 v[176:191], a[36:39], a[4:7], v[176:191]
    ds_read_b128 a[28:31], v5 offset:12288
    s_add_u32 m0, s58, 16384
    s_add_u32 s47, s57, 262144
    buffer_load_dwordx4 v11, s[24:27], s47 offen lds
    v_mfma_f32_32x32x16_bf16 v[192:207], a[32:35], a[8:11], v[192:207]
    s_add_u32 m0, s58, 18432
    s_add_u32 s47, s57, 278528
    buffer_load_dwordx4 v11, s[24:27], s47 offen lds
    v_mfma_f32_32x32x16_bf16 v[208:223], a[36:39], a[8:11], v[208:223]
    v_mfma_f32_32x32x16_bf16 v[224:239], a[32:35], a[12:15], v[224:239]
    s_add_u32 m0, s58, 20480
    s_add_u32 s47, s57, 294912
    buffer_load_dwordx4 v11, s[24:27], s47 offen lds
    v_mfma_f32_32x32x16_bf16 v[240:255], a[36:39], a[12:15], v[240:255]
    s_waitcnt lgkmcnt(0)
    v_mfma_f32_32x32x16_bf16 v[128:143], a[40:43], a[16:19], v[128:143]
    v_mfma_f32_32x32x16_bf16 v[144:159], a[44:47], a[16:19], v[144:159]
    v_mfma_f32_32x32x16_bf16 v[160:175], a[40:43], a[20:23], v[160:175]
    v_mfma_f32_32x32x16_bf16 v[176:191], a[44:47], a[20:23], v[176:191]
    s_add_u32 m0, s58, 22528
    s_add_u32 s47, s57, 311296
    buffer_load_dwordx4 v11, s[24:27], s47 offen lds
    s_add_u32 m0, s58, 32768
    s_add_u32 s47, s57, 327680
    buffer_load_dwordx4 v11, s[24:27], s47 offen lds
    v_mfma_f32_32x32x16_bf16 v[192:207], a[40:43], a[24:27], v[192:207]
    s_add_u32 m0, s58, 34816
    s_add_u32 s47, s57, 344064
    buffer_load_dwordx4 v11, s[24:27], s47 offen lds
    v_mfma_f32_32x32x16_bf16 v[208:223], a[44:47], a[24:27], v[208:223]
    s_and_b32 s48, s2, 7
    s_lshl_b32 s48, s48, 2
    s_lshr_b32 s49, s2, 6
    v_mfma_f32_32x32x16_bf16 v[224:239], a[40:43], a[28:31], v[224:239]
    s_add_u32 s48, s48, s49
    s_bfe_u32 s55, s2, 0x30003
    s_and_b32 s52, s36, 1
    v_mfma_f32_32x32x16_bf16 v[240:255], a[44:47], a[28:31], v[240:255]
    s_lshr_b32 s53, s36, 1
    s_lshl_b32 s48, s48, 1
    s_add_u32 s54, s48, s53
    s_mul_i32 s44, s38, 458752
    s_lshl_b32 s47, s39, 13
    s_add_u32 s44, s44, s47
    s_lshl_b32 s47, s36, 11
    s_add_u32 s44, s44, s47
    v_mov_b32 v112, 0xbfb8aa3b
    s_lshl_b32 s51, s38, 4
    s_add_u32 s51, s51, s39
    s_lshl_b32 s51, s51, 4
    s_add_u32 s51, s51, 0x1111000
    v_pk_mul_f32 v[128:129], v[128:129], v[112:113] op_sel_hi:[1,0]
    v_pk_mul_f32 v[130:131], v[130:131], v[112:113] op_sel_hi:[1,0]
    v_pk_mul_f32 v[132:133], v[132:133], v[112:113] op_sel_hi:[1,0]
    v_pk_mul_f32 v[134:135], v[134:135], v[112:113] op_sel_hi:[1,0]
    v_exp_f32 v128, v128
    v_exp_f32 v129, v129
    v_exp_f32 v130, v130
    v_exp_f32 v131, v131
    v_exp_f32 v132, v132
    v_exp_f32 v133, v133
    v_exp_f32 v134, v134
    v_exp_f32 v135, v135
    v_pk_add_f32 v[128:129], v[128:129], 1.0 op_sel_hi:[1,0]
    v_pk_add_f32 v[130:131], v[130:131], 1.0 op_sel_hi:[1,0]
    v_pk_add_f32 v[132:133], v[132:133], 1.0 op_sel_hi:[1,0]
    v_pk_add_f32 v[134:135], v[134:135], 1.0 op_sel_hi:[1,0]
    v_rcp_f32 v128, v128
    v_rcp_f32 v129, v129
    v_rcp_f32 v130, v130
    v_rcp_f32 v131, v131
    v_rcp_f32 v132, v132
    v_rcp_f32 v133, v133
    v_rcp_f32 v134, v134
    v_rcp_f32 v135, v135
    v_pk_mul_f32 v[128:129], v[128:129], v[144:145]
    v_pk_mul_f32 v[130:131], v[130:131], v[146:147]
    v_pk_mul_f32 v[132:133], v[132:133], v[148:149]
    v_pk_mul_f32 v[134:135], v[134:135], v[150:151]
    v_cvt_pk_bf16_f32 v96, v128, v129
    v_cvt_pk_bf16_f32 v97, v130, v131
    v_cvt_pk_bf16_f32 v98, v132, v133
    v_cvt_pk_bf16_f32 v99, v134, v135
    buffer_store_dwordx4 v[96:99], v10, s[32:35], s44 offen offset:0 sc1
    s_waitcnt vmcnt(32)
    s_barrier
    v_xor_b32 v72, 16, v127
    v_xor_b32 v73, 16, v14
    ds_read_b128 a[48:51], v127 offset:0
    ds_read_b128 a[64:67], v72 offset:256
    ds_read_b128 a[52:55], v127 offset:4096
    ds_read_b128 a[68:71], v72 offset:4352
    ds_read_b128 a[56:59], v127 offset:8192
    ds_read_b128 a[72:75], v72 offset:8448
    ds_read_b128 a[60:63], v127 offset:12288
    ds_read_b128 a[76:79], v72 offset:12544
    ds_read_b128 v[64:67], v14
    ds_read_b128 v[68:71], v73
    v_pk_mul_f32 v[136:137], v[136:137], v[112:113] op_sel_hi:[1,0]
    v_pk_mul_f32 v[138:139], v[138:139], v[112:113] op_sel_hi:[1,0]
    v_pk_mul_f32 v[140:141], v[140:141], v[112:113] op_sel_hi:[1,0]
    v_pk_mul_f32 v[142:143], v[142:143], v[112:113] op_sel_hi:[1,0]
    v_exp_f32 v136, v136
    v_exp_f32 v137, v137
    v_exp_f32 v138, v138
    v_exp_f32 v139, v139
    v_exp_f32 v140, v140
    v_exp_f32 v141, v141
    v_exp_f32 v142, v142
    v_exp_f32 v143, v143
    v_pk_add_f32 v[136:137], v[136:137], 1.0 op_sel_hi:[1,0]
    v_pk_add_f32 v[138:139], v[138:139], 1.0 op_sel_hi:[1,0]
    v_pk_add_f32 v[140:141], v[140:141], 1.0 op_sel_hi:[1,0]
    v_pk_add_f32 v[142:143], v[142:143], 1.0 op_sel_hi:[1,0]
    v_rcp_f32 v136, v136
    v_rcp_f32 v137, v137
    v_rcp_f32 v138, v138
    v_rcp_f32 v139, v139
    v_rcp_f32 v140, v140
    v_rcp_f32 v141, v141
    v_rcp_f32 v142, v142
    v_rcp_f32 v143, v143
    v_pk_mul_f32 v[136:137], v[136:137], v[152:153]
    v_pk_mul_f32 v[138:139], v[138:139], v[154:155]
    v_pk_mul_f32 v[140:141], v[140:141], v[156:157]
    v_pk_mul_f32 v[142:143], v[142:143], v[158:159]
    v_cvt_pk_bf16_f32 v100, v136, v137
    v_cvt_pk_bf16_f32 v101, v138, v139
    v_cvt_pk_bf16_f32 v102, v140, v141
    v_cvt_pk_bf16_f32 v103, v142, v143
    buffer_store_dwordx4 v[100:103], v10, s[32:35], s44 offen offset:1024 sc1
    s_add_u32 s44, s44, 114688
    v_pk_mul_f32 v[160:161], v[160:161], v[112:113] op_sel_hi:[1,0]
    v_pk_mul_f32 v[162:163], v[162:163], v[112:113] op_sel_hi:[1,0]
    v_pk_mul_f32 v[164:165], v[164:165], v[112:113] op_sel_hi:[1,0]
    v_pk_mul_f32 v[166:167], v[166:167], v[112:113] op_sel_hi:[1,0]
    v_exp_f32 v160, v160
    v_exp_f32 v161, v161
    v_exp_f32 v162, v162
    v_exp_f32 v163, v163
    v_exp_f32 v164, v164
    v_exp_f32 v165, v165
    v_exp_f32 v166, v166
    v_exp_f32 v167, v167
    v_pk_add_f32 v[160:161], v[160:161], 1.0 op_sel_hi:[1,0]
    v_pk_add_f32 v[162:163], v[162:163], 1.0 op_sel_hi:[1,0]
    v_pk_add_f32 v[164:165], v[164:165], 1.0 op_sel_hi:[1,0]
    v_pk_add_f32 v[166:167], v[166:167], 1.0 op_sel_hi:[1,0]
    v_rcp_f32 v160, v160
    v_rcp_f32 v161, v161
    v_rcp_f32 v162, v162
    v_rcp_f32 v163, v163
    v_rcp_f32 v164, v164
    v_rcp_f32 v165, v165
    v_rcp_f32 v166, v166
    v_rcp_f32 v167, v167
    v_pk_mul_f32 v[160:161], v[160:161], v[176:177]
    v_pk_mul_f32 v[162:163], v[162:163], v[178:179]
    v_pk_mul_f32 v[164:165], v[164:165], v[180:181]
    v_pk_mul_f32 v[166:167], v[166:167], v[182:183]
    v_cvt_pk_bf16_f32 v104, v160, v161
    v_cvt_pk_bf16_f32 v105, v162, v163
    v_cvt_pk_bf16_f32 v106, v164, v165
    v_cvt_pk_bf16_f32 v107, v166, v167
    buffer_store_dwordx4 v[104:107], v10, s[32:35], s44 offen offset:0 sc1
    v_pk_mul_f32 v[168:169], v[168:169], v[112:113] op_sel_hi:[1,0]
    v_pk_mul_f32 v[170:171], v[170:171], v[112:113] op_sel_hi:[1,0]
    v_pk_mul_f32 v[172:173], v[172:173], v[112:113] op_sel_hi:[1,0]
    v_pk_mul_f32 v[174:175], v[174:175], v[112:113] op_sel_hi:[1,0]
    v_exp_f32 v168, v168
    v_exp_f32 v169, v169
    v_exp_f32 v170, v170
    v_exp_f32 v171, v171
    v_exp_f32 v172, v172
    v_exp_f32 v173, v173
    v_exp_f32 v174, v174
    v_exp_f32 v175, v175
    v_pk_add_f32 v[168:169], v[168:169], 1.0 op_sel_hi:[1,0]
    v_pk_add_f32 v[170:171], v[170:171], 1.0 op_sel_hi:[1,0]
    v_pk_add_f32 v[172:173], v[172:173], 1.0 op_sel_hi:[1,0]
    v_pk_add_f32 v[174:175], v[174:175], 1.0 op_sel_hi:[1,0]
    v_rcp_f32 v168, v168
    v_rcp_f32 v169, v169
    v_rcp_f32 v170, v170
    v_rcp_f32 v171, v171
    v_rcp_f32 v172, v172
    v_rcp_f32 v173, v173
    v_rcp_f32 v174, v174
    v_rcp_f32 v175, v175
    v_pk_mul_f32 v[168:169], v[168:169], v[184:185]
    v_pk_mul_f32 v[170:171], v[170:171], v[186:187]
    v_pk_mul_f32 v[172:173], v[172:173], v[188:189]
    v_pk_mul_f32 v[174:175], v[174:175], v[190:191]
    v_cvt_pk_bf16_f32 v108, v168, v169
    v_cvt_pk_bf16_f32 v109, v170, v171
    v_cvt_pk_bf16_f32 v110, v172, v173
    v_cvt_pk_bf16_f32 v111, v174, v175
    buffer_store_dwordx4 v[108:111], v10, s[32:35], s44 offen offset:1024 sc1
    s_add_u32 s44, s44, 114688
    v_pk_mul_f32 v[192:193], v[192:193], v[112:113] op_sel_hi:[1,0]
    v_pk_mul_f32 v[194:195], v[194:195], v[112:113] op_sel_hi:[1,0]
    v_pk_mul_f32 v[196:197], v[196:197], v[112:113] op_sel_hi:[1,0]
    v_pk_mul_f32 v[198:199], v[198:199], v[112:113] op_sel_hi:[1,0]
    v_exp_f32 v192, v192
    v_exp_f32 v193, v193
    v_exp_f32 v194, v194
    v_exp_f32 v195, v195
    v_exp_f32 v196, v196
    v_exp_f32 v197, v197
    v_exp_f32 v198, v198
    v_exp_f32 v199, v199
    v_pk_add_f32 v[192:193], v[192:193], 1.0 op_sel_hi:[1,0]
    v_pk_add_f32 v[194:195], v[194:195], 1.0 op_sel_hi:[1,0]
    v_pk_add_f32 v[196:197], v[196:197], 1.0 op_sel_hi:[1,0]
    v_pk_add_f32 v[198:199], v[198:199], 1.0 op_sel_hi:[1,0]
    v_rcp_f32 v192, v192
    v_rcp_f32 v193, v193
    v_rcp_f32 v194, v194
    v_rcp_f32 v195, v195
    v_rcp_f32 v196, v196
    v_rcp_f32 v197, v197
    v_rcp_f32 v198, v198
    v_rcp_f32 v199, v199
    v_pk_mul_f32 v[192:193], v[192:193], v[208:209]
    v_pk_mul_f32 v[194:195], v[194:195], v[210:211]
    v_pk_mul_f32 v[196:197], v[196:197], v[212:213]
    v_pk_mul_f32 v[198:199], v[198:199], v[214:215]
    v_cvt_pk_bf16_f32 v96, v192, v193
    v_cvt_pk_bf16_f32 v97, v194, v195
    v_cvt_pk_bf16_f32 v98, v196, v197
    v_cvt_pk_bf16_f32 v99, v198, v199
    buffer_store_dwordx4 v[96:99], v10, s[32:35], s44 offen offset:0 sc1
    v_pk_mul_f32 v[200:201], v[200:201], v[112:113] op_sel_hi:[1,0]
    v_pk_mul_f32 v[202:203], v[202:203], v[112:113] op_sel_hi:[1,0]
    v_pk_mul_f32 v[204:205], v[204:205], v[112:113] op_sel_hi:[1,0]
    v_pk_mul_f32 v[206:207], v[206:207], v[112:113] op_sel_hi:[1,0]
    v_exp_f32 v200, v200
    v_exp_f32 v201, v201
    v_exp_f32 v202, v202
    v_exp_f32 v203, v203
    v_exp_f32 v204, v204
    v_exp_f32 v205, v205
    v_exp_f32 v206, v206
    v_exp_f32 v207, v207
    v_pk_add_f32 v[200:201], v[200:201], 1.0 op_sel_hi:[1,0]
    v_pk_add_f32 v[202:203], v[202:203], 1.0 op_sel_hi:[1,0]
    v_pk_add_f32 v[204:205], v[204:205], 1.0 op_sel_hi:[1,0]
    v_pk_add_f32 v[206:207], v[206:207], 1.0 op_sel_hi:[1,0]
    v_rcp_f32 v200, v200
    v_rcp_f32 v201, v201
    v_rcp_f32 v202, v202
    v_rcp_f32 v203, v203
    v_rcp_f32 v204, v204
    v_rcp_f32 v205, v205
    v_rcp_f32 v206, v206
    v_rcp_f32 v207, v207
    v_pk_mul_f32 v[200:201], v[200:201], v[216:217]
    v_pk_mul_f32 v[202:203], v[202:203], v[218:219]
    v_pk_mul_f32 v[204:205], v[204:205], v[220:221]
    v_pk_mul_f32 v[206:207], v[206:207], v[222:223]
    v_cvt_pk_bf16_f32 v100, v200, v201
    v_cvt_pk_bf16_f32 v101, v202, v203
    v_cvt_pk_bf16_f32 v102, v204, v205
    v_cvt_pk_bf16_f32 v103, v206, v207
    buffer_store_dwordx4 v[100:103], v10, s[32:35], s44 offen offset:1024 sc1
    s_add_u32 s44, s44, 114688
    v_pk_mul_f32 v[224:225], v[224:225], v[112:113] op_sel_hi:[1,0]
    v_pk_mul_f32 v[226:227], v[226:227], v[112:113] op_sel_hi:[1,0]
    v_pk_mul_f32 v[228:229], v[228:229], v[112:113] op_sel_hi:[1,0]
    v_pk_mul_f32 v[230:231], v[230:231], v[112:113] op_sel_hi:[1,0]
    v_exp_f32 v224, v224
    v_exp_f32 v225, v225
    v_exp_f32 v226, v226
    v_exp_f32 v227, v227
    v_exp_f32 v228, v228
    v_exp_f32 v229, v229
    v_exp_f32 v230, v230
    v_exp_f32 v231, v231
    v_pk_add_f32 v[224:225], v[224:225], 1.0 op_sel_hi:[1,0]
    v_pk_add_f32 v[226:227], v[226:227], 1.0 op_sel_hi:[1,0]
    v_pk_add_f32 v[228:229], v[228:229], 1.0 op_sel_hi:[1,0]
    v_pk_add_f32 v[230:231], v[230:231], 1.0 op_sel_hi:[1,0]
    v_rcp_f32 v224, v224
    v_rcp_f32 v225, v225
    v_rcp_f32 v226, v226
    v_rcp_f32 v227, v227
    v_rcp_f32 v228, v228
    v_rcp_f32 v229, v229
    v_rcp_f32 v230, v230
    v_rcp_f32 v231, v231
    v_pk_mul_f32 v[224:225], v[224:225], v[240:241]
    v_pk_mul_f32 v[226:227], v[226:227], v[242:243]
    v_pk_mul_f32 v[228:229], v[228:229], v[244:245]
    v_pk_mul_f32 v[230:231], v[230:231], v[246:247]
    v_cvt_pk_bf16_f32 v104, v224, v225
    v_cvt_pk_bf16_f32 v105, v226, v227
    v_cvt_pk_bf16_f32 v106, v228, v229
    v_cvt_pk_bf16_f32 v107, v230, v231
    buffer_store_dwordx4 v[104:107], v10, s[32:35], s44 offen offset:0 sc1
    v_pk_mul_f32 v[232:233], v[232:233], v[112:113] op_sel_hi:[1,0]
    v_pk_mul_f32 v[234:235], v[234:235], v[112:113] op_sel_hi:[1,0]
    v_pk_mul_f32 v[236:237], v[236:237], v[112:113] op_sel_hi:[1,0]
    v_pk_mul_f32 v[238:239], v[238:239], v[112:113] op_sel_hi:[1,0]
    v_exp_f32 v232, v232
    v_exp_f32 v233, v233
    v_exp_f32 v234, v234
    v_exp_f32 v235, v235
    v_exp_f32 v236, v236
    v_exp_f32 v237, v237
    v_exp_f32 v238, v238
    v_exp_f32 v239, v239
    v_pk_add_f32 v[232:233], v[232:233], 1.0 op_sel_hi:[1,0]
    v_pk_add_f32 v[234:235], v[234:235], 1.0 op_sel_hi:[1,0]
    v_pk_add_f32 v[236:237], v[236:237], 1.0 op_sel_hi:[1,0]
    v_pk_add_f32 v[238:239], v[238:239], 1.0 op_sel_hi:[1,0]
    v_rcp_f32 v232, v232
    v_rcp_f32 v233, v233
    v_rcp_f32 v234, v234
    v_rcp_f32 v235, v235
    v_rcp_f32 v236, v236
    v_rcp_f32 v237, v237
    v_rcp_f32 v238, v238
    v_rcp_f32 v239, v239
    v_pk_mul_f32 v[232:233], v[232:233], v[248:249]
    v_pk_mul_f32 v[234:235], v[234:235], v[250:251]
    v_pk_mul_f32 v[236:237], v[236:237], v[252:253]
    v_pk_mul_f32 v[238:239], v[238:239], v[254:255]
    v_cvt_pk_bf16_f32 v108, v232, v233
    v_cvt_pk_bf16_f32 v109, v234, v235
    v_cvt_pk_bf16_f32 v110, v236, v237
    v_cvt_pk_bf16_f32 v111, v238, v239
    buffer_store_dwordx4 v[108:111], v10, s[32:35], s44 offen offset:1024 sc1
    s_cmp_lg_u32 s36, 0
    s_cbranch_scc1 L_ct4
    s_getpc_b64 s[48:49]
L_pc4:
    s_add_u32 s48, s48, L_C-L_pc4
    s_addc_u32 s49, s49, 0
    s_lshr_b32 s47, s2, 3
    s_mul_i32 s47, s47, 384
    v_lshl_add_u32 v124, v0, 7, s47
    v_min_u32 v124, L_code_end-L_C-4, v124
    v_mov_b32 v125, 0
    v_lshl_add_u64 v[124:125], v[124:125], 0, s[48:49]
    s_mov_b64 exec, 7
    global_load_dword a252, v[124:125], off
    s_mov_b64 exec, -1
L_ct4:
    s_waitcnt lgkmcnt(0)
    v_mfma_f32_16x16x32_bf16 v[24:27], a[48:51], a[80:83], 0
    v_lshlrev_b32 v48, 16, v64
    v_mfma_f32_16x16x32_bf16 v[32:35], a[48:51], a[96:99], 0
    v_and_b32 v49, 0xffff0000, v64
    v_mfma_f32_16x16x32_bf16 v[28:31], a[64:67], a[80:83], 0
    v_lshlrev_b32 v50, 16, v65
    v_mfma_f32_16x16x32_bf16 v[36:39], a[64:67], a[96:99], 0
    v_and_b32 v51, 0xffff0000, v65
    v_mfma_f32_16x16x32_bf16 v[24:27], a[52:55], a[84:87], v[24:27]
    v_lshlrev_b32 v52, 16, v66
    v_mfma_f32_16x16x32_bf16 v[32:35], a[52:55], a[100:103], v[32:35]
    v_and_b32 v53, 0xffff0000, v66
    v_mfma_f32_16x16x32_bf16 v[28:31], a[68:71], a[84:87], v[28:31]
    v_lshlrev_b32 v54, 16, v67
    v_mfma_f32_16x16x32_bf16 v[36:39], a[68:71], a[100:103], v[36:39]
    v_and_b32 v55, 0xffff0000, v67
    v_mfma_f32_16x16x32_bf16 v[24:27], a[56:59], a[88:91], v[24:27]
    v_lshlrev_b32 v56, 16, v68
    v_mfma_f32_16x16x32_bf16 v[32:35], a[56:59], a[104:107], v[32:35]
    v_and_b32 v57, 0xffff0000, v68
    v_mfma_f32_16x16x32_bf16 v[28:31], a[72:75], a[88:91], v[28:31]
    v_lshlrev_b32 v58, 16, v69
    v_mfma_f32_16x16x32_bf16 v[36:39], a[72:75], a[104:107], v[36:39]
    v_and_b32 v59, 0xffff0000, v69
    v_mfma_f32_16x16x32_bf16 v[24:27], a[60:63], a[92:95], v[24:27]
    v_lshlrev_b32 v60, 16, v70
    v_mfma_f32_16x16x32_bf16 v[32:35], a[60:63], a[108:111], v[32:35]
    v_and_b32 v61, 0xffff0000, v70
    v_mfma_f32_16x16x32_bf16 v[28:31], a[76:79], a[92:95], v[28:31]
    v_lshlrev_b32 v62, 16, v71
    v_mfma_f32_16x16x32_bf16 v[36:39], a[76:79], a[108:111], v[36:39]
    v_and_b32 v63, 0xffff0000, v71
    s_nop 0
    v_pk_mul_f32 v[72:73], v[24:25], v[80:81]
    s_nop 0
    v_pk_mul_f32 v[74:75], v[32:33], v[80:81]
    v_pk_fma_f32 v[72:73], v[32:33], v[88:89], v[72:73]
    v_pk_fma_f32 v[74:75], v[24:25], v[88:89], v[74:75] neg_lo:[1,0,0] neg_hi:[1,0,0]
    v_cvt_pk_bf16_f32 v40, v72, v73
    v_cvt_pk_bf16_f32 v44, v74, v75
    v_pk_mul_f32 v[76:77], v[26:27], v[82:83]
    v_pk_mul_f32 v[78:79], v[34:35], v[82:83]
    v_pk_fma_f32 v[76:77], v[34:35], v[90:91], v[76:77]
    v_pk_fma_f32 v[78:79], v[26:27], v[90:91], v[78:79] neg_lo:[1,0,0] neg_hi:[1,0,0]
    v_cvt_pk_bf16_f32 v41, v76, v77
    v_cvt_pk_bf16_f32 v45, v78, v79
    v_pk_mul_f32 v[72:73], v[28:29], v[84:85]
    v_pk_mul_f32 v[74:75], v[36:37], v[84:85]
    v_pk_fma_f32 v[72:73], v[36:37], v[92:93], v[72:73]
    v_pk_fma_f32 v[74:75], v[28:29], v[92:93], v[74:75] neg_lo:[1,0,0] neg_hi:[1,0,0]
    v_cvt_pk_bf16_f32 v42, v72, v73
    v_cvt_pk_bf16_f32 v46, v74, v75
    v_pk_mul_f32 v[76:77], v[30:31], v[86:87]
    v_pk_mul_f32 v[78:79], v[38:39], v[86:87]
    v_pk_fma_f32 v[76:77], v[38:39], v[94:95], v[76:77]
    v_pk_fma_f32 v[78:79], v[30:31], v[94:95], v[78:79] neg_lo:[1,0,0] neg_hi:[1,0,0]
    v_cvt_pk_bf16_f32 v43, v76, v77
    v_cvt_pk_bf16_f32 v47, v78, v79
    s_nop 0
    v_mfma_f32_16x16x32_bf16 v[24:27], a[112:115], v[40:43], 0
    v_mfma_f32_16x16x32_bf16 v[32:35], a[112:115], v[44:47], 0
    v_mfma_f32_16x16x32_bf16 v[28:31], a[116:119], v[40:43], 0
    v_mfma_f32_16x16x32_bf16 v[36:39], a[116:119], v[44:47], 0
    v_mfma_f32_16x16x32_bf16 v[24:27], a[120:123], v[44:47], v[24:27]
    v_mfma_f32_16x16x32_bf16 v[32:35], a[128:131], v[40:43], v[32:35]
    v_mfma_f32_16x16x32_bf16 v[28:31], a[124:127], v[44:47], v[28:31]
    v_mfma_f32_16x16x32_bf16 v[36:39], a[132:135], v[40:43], v[36:39]
    s_mul_i32 s96, s45, 528
    s_lshl_b32 s97, s36, 10
    s_add_u32 s96, s96, s97
    s_add_u32 s96, s96, 0xe40000
    s_add_u32 s97, s96, 4224
    v_and_b32 v96, 127, v11
    v_lshrrev_b32 v97, 3, v1
    v_mul_u32_u24 v9, 4224, v97
    v_add_u32 v9, v9, v96
    s_mul_i32 s56, s54, 114688
    s_mul_i32 s46, s52, 57344
    s_add_u32 s56, s56, s46
    s_lshr_b32 s59, s54, 4
    s_lshl_b32 s59, s59, 10
    s_bfe_u32 s46, s54, 0x20001
    s_lshl_b32 s48, s46, 8
    s_add_u32 s59, s59, s48
    s_lshl_b32 s38, s46, 13
    s_bfe_u32 s46, s54, 0x10003
    s_lshl_b32 s46, s46, 7
    s_add_u32 s59, s59, s46
    s_mul_i32 s46, s36, 135168
    s_add_u32 s59, s59, s46
    s_add_u32 s59, s59, 0xe40000
    s_lshr_b32 s46, s54, 3
    s_lshl_b32 s46, s46, 18
    s_add_u32 s38, s38, s46
    s_lshl_b32 s46, s36, 16
    s_add_u32 s38, s38, s46
    s_lshl_b32 s46, s55, 7
    s_add_u32 s38, s38, s46
    v_lshrrev_b32 v96, 4, v1
    v_xor_b32 v96, v96, v1
    v_and_b32 v96, 7, v96
    v_lshlrev_b32 v96, 4, v96
    v_pk_mul_f32 v[72:73], v[24:25], v[48:49]
    v_pk_mul_f32 v[74:75], v[32:33], v[48:49]
    v_pk_fma_f32 v[72:73], v[32:33], v[56:57], v[72:73] neg_lo:[1,0,0] neg_hi:[1,0,0]
    v_pk_fma_f32 v[74:75], v[24:25], v[56:57], v[74:75]
    v_cvt_pk_bf16_f32 v40, v72, v73
    v_cvt_pk_bf16_f32 v44, -v74, -v75
    v_pk_mul_f32 v[76:77], v[26:27], v[50:51]
    v_pk_mul_f32 v[78:79], v[34:35], v[50:51]
    v_pk_fma_f32 v[76:77], v[34:35], v[58:59], v[76:77] neg_lo:[1,0,0] neg_hi:[1,0,0]
    v_pk_fma_f32 v[78:79], v[26:27], v[58:59], v[78:79]
    v_cvt_pk_bf16_f32 v41, v76, v77
    v_cvt_pk_bf16_f32 v45, -v78, -v79
    s_waitcnt vmcnt(0)
    s_barrier
    s_cmp_lg_u32 s36, 0
    s_cbranch_scc1 L_f3
    v_mov_b32 v124, s37
    v_mov_b32 v125, 0
    s_mov_b64 exec, 1
    buffer_store_dword v124, v125, s[32:35], s51 offen sc1
    s_mov_b64 exec, -1
L_f3:
    v_pk_mul_f32 v[72:73], v[28:29], v[52:53]
    v_pk_mul_f32 v[74:75], v[36:37], v[52:53]
    v_pk_fma_f32 v[72:73], v[36:37], v[60:61], v[72:73] neg_lo:[1,0,0] neg_hi:[1,0,0]
    v_pk_fma_f32 v[74:75], v[28:29], v[60:61], v[74:75]
    v_cvt_pk_bf16_f32 v42, v72, v73
    v_cvt_pk_bf16_f32 v46, -v74, -v75
    v_pk_mul_f32 v[76:77], v[30:31], v[54:55]
    v_pk_mul_f32 v[78:79], v[38:39], v[54:55]
    v_pk_fma_f32 v[76:77], v[38:39], v[62:63], v[76:77] neg_lo:[1,0,0] neg_hi:[1,0,0]
    v_pk_fma_f32 v[78:79], v[30:31], v[62:63], v[78:79]
    v_cvt_pk_bf16_f32 v43, v76, v77
    v_cvt_pk_bf16_f32 v47, -v78, -v79
    s_add_u32 m0, s58, 36864
    s_add_u32 s47, s57, 360448
    buffer_load_dwordx4 v11, s[24:27], s47 offen lds
    s_add_u32 m0, s58, 38912
    s_add_u32 s47, s57, 376832
    buffer_load_dwordx4 v11, s[24:27], s47 offen lds
    v_mfma_f32_16x16x32_bf16 v[24:27], a[112:115], v[40:43], 0
    v_mfma_f32_16x16x32_bf16 v[32:35], a[112:115], v[44:47], 0
    v_mfma_f32_16x16x32_bf16 v[28:31], a[116:119], v[40:43], 0
    v_mfma_f32_16x16x32_bf16 v[36:39], a[116:119], v[44:47], 0
    v_mfma_f32_16x16x32_bf16 v[24:27], a[120:123], v[44:47], v[24:27]
    v_mfma_f32_16x16x32_bf16 v[32:35], a[128:131], v[40:43], v[32:35]
    v_mfma_f32_16x16x32_bf16 v[28:31], a[124:127], v[44:47], v[28:31]
    v_mfma_f32_16x16x32_bf16 v[36:39], a[132:135], v[40:43], v[36:39]
    s_add_u32 m0, s58, 49152
    s_add_u32 s47, s57, 393216
    buffer_load_dwordx4 v11, s[24:27], s47 offen lds
    s_add_u32 m0, s58, 51200
    s_add_u32 s47, s57, 409600
    buffer_load_dwordx4 v11, s[24:27], s47 offen lds
    v_lshl_add_u32 v12, v97, 10, v96
    v_xor_b32 v7, 64, v12
    v_bfe_u32 v96, v1, 4, 1
    v_lshl_add_u32 v8, v96, 5, v22
    v_and_b32 v96, 3, v1
    v_lshl_add_u32 v8, v96, 3, v8
    s_lshl_b32 s46, s53, 6
    s_add_u32 s46, s46, 16384
    v_xor_b32 v8, s46, v8
    v_lshrrev_b32 v96, 5, v1
    v_lshlrev_b32 v96, 1, v96
    v_bfe_u32 v97, v1, 1, 3
    v_xor_b32 v96, v96, v97
    v_lshlrev_b32 v96, 4, v96
    v_and_b32 v97, 31, v1
    v_lshl_add_u32 v96, v97, 7, v96
    s_lshl_b32 s46, s53, 12
    s_lshl_b32 s48, s52, 6
    s_add_u32 s46, s46, s48
    v_xor_b32 v96, s46, v96
    v_add_u32 v14, 81920, v96
    s_lshl_b32 s46, s36, 12
    s_add_u32 s46, s46, 147456
    v_add_u32 v13, s46, v10
    v_pk_mul_f32 v[72:73], v[24:25], v[80:81]
    v_pk_mul_f32 v[74:75], v[32:33], v[80:81]
    v_pk_fma_f32 v[72:73], v[32:33], v[88:89], v[72:73]
    v_pk_fma_f32 v[74:75], v[24:25], v[88:89], v[74:75] neg_lo:[1,0,0] neg_hi:[1,0,0]
    v_cvt_pk_bf16_f32 v40, v72, v73
    v_cvt_pk_bf16_f32 v44, v74, v75
    v_pk_mul_f32 v[76:77], v[26:27], v[82:83]
    v_pk_mul_f32 v[78:79], v[34:35], v[82:83]
    v_pk_fma_f32 v[76:77], v[34:35], v[90:91], v[76:77]
    v_pk_fma_f32 v[78:79], v[26:27], v[90:91], v[78:79] neg_lo:[1,0,0] neg_hi:[1,0,0]
    v_cvt_pk_bf16_f32 v41, v76, v77
    v_cvt_pk_bf16_f32 v45, v78, v79
    s_add_u32 m0, s58, 53248
    s_add_u32 s47, s57, 425984
    buffer_load_dwordx4 v11, s[24:27], s47 offen lds
    s_add_u32 m0, s58, 55296
    s_add_u32 s47, s57, 442368
    buffer_load_dwordx4 v11, s[24:27], s47 offen lds
    v_pk_mul_f32 v[72:73], v[28:29], v[84:85]
    v_pk_mul_f32 v[74:75], v[36:37], v[84:85]
    v_pk_fma_f32 v[72:73], v[36:37], v[92:93], v[72:73]
    v_pk_fma_f32 v[74:75], v[28:29], v[92:93], v[74:75] neg_lo:[1,0,0] neg_hi:[1,0,0]
    v_cvt_pk_bf16_f32 v42, v72, v73
    v_cvt_pk_bf16_f32 v46, v74, v75
    v_pk_mul_f32 v[76:77], v[30:31], v[86:87]
    v_pk_mul_f32 v[78:79], v[38:39], v[86:87]
    v_pk_fma_f32 v[76:77], v[38:39], v[94:95], v[76:77]
    v_pk_fma_f32 v[78:79], v[30:31], v[94:95], v[78:79] neg_lo:[1,0,0] neg_hi:[1,0,0]
    v_cvt_pk_bf16_f32 v43, v76, v77
    v_cvt_pk_bf16_f32 v47, v78, v79
    ds_write_b128 v122, v[40:43]
    ds_write_b128 v122, v[44:47] offset:4096
    s_add_u32 m0, s58, 65536
    s_add_u32 s47, s57, 458752
    buffer_load_dwordx4 v11, s[24:27], s47 offen lds
    s_add_u32 m0, s58, 67584
    s_add_u32 s47, s57, 475136
    buffer_load_dwordx4 v11, s[24:27], s47 offen lds
    s_waitcnt lgkmcnt(0)
    s_barrier
    ds_read_b64_tr_b16 a[48:49], v123 offset:0
    ds_read_b64_tr_b16 a[50:51], v23 offset:256
    ds_read_b64_tr_b16 a[64:65], v123 offset:8
    ds_read_b64_tr_b16 a[66:67], v23 offset:264
    ds_read_b64_tr_b16 a[52:53], v123 offset:1024
    ds_read_b64_tr_b16 a[54:55], v23 offset:1280
    ds_read_b64_tr_b16 a[68:69], v123 offset:1032
    ds_read_b64_tr_b16 a[70:71], v23 offset:1288
    ds_read_b64_tr_b16 a[56:57], v123 offset:2048
    ds_read_b64_tr_b16 a[58:59], v23 offset:2304
    ds_read_b64_tr_b16 a[72:73], v123 offset:2056
    ds_read_b64_tr_b16 a[74:75], v23 offset:2312
    ds_read_b64_tr_b16 a[60:61], v123 offset:3072
    ds_read_b64_tr_b16 a[62:63], v23 offset:3328
    ds_read_b64_tr_b16 a[76:77], v123 offset:3080
    ds_read_b64_tr_b16 a[78:79], v23 offset:3336
    s_waitcnt lgkmcnt(14)
    v_mfma_f32_16x16x32_bf16 v[24:27], a[48:51], a[80:83], 0
    v_mfma_f32_16x16x32_bf16 v[32:35], a[48:51], a[96:99], 0
    s_waitcnt lgkmcnt(12)
    v_mfma_f32_16x16x32_bf16 v[28:31], a[64:67], a[80:83], 0
    v_mfma_f32_16x16x32_bf16 v[36:39], a[64:67], a[96:99], 0
    s_waitcnt lgkmcnt(10)
    v_mfma_f32_16x16x32_bf16 v[24:27], a[52:55], a[84:87], v[24:27]
    v_mfma_f32_16x16x32_bf16 v[32:35], a[52:55], a[100:103], v[32:35]
    s_waitcnt lgkmcnt(8)
    v_mfma_f32_16x16x32_bf16 v[28:31], a[68:71], a[84:87], v[28:31]
    v_mfma_f32_16x16x32_bf16 v[36:39], a[68:71], a[100:103], v[36:39]
    s_waitcnt lgkmcnt(6)
    v_mfma_f32_16x16x32_bf16 v[24:27], a[56:59], a[88:91], v[24:27]
    v_mfma_f32_16x16x32_bf16 v[32:35], a[56:59], a[104:107], v[32:35]
    s_waitcnt lgkmcnt(4)
    v_mfma_f32_16x16x32_bf16 v[28:31], a[72:75], a[88:91], v[28:31]
    v_mfma_f32_16x16x32_bf16 v[36:39], a[72:75], a[104:107], v[36:39]
    s_waitcnt lgkmcnt(2)
    v_mfma_f32_16x16x32_bf16 v[24:27], a[60:63], a[92:95], v[24:27]
    v_mfma_f32_16x16x32_bf16 v[32:35], a[60:63], a[108:111], v[32:35]
    s_waitcnt lgkmcnt(0)
    v_mfma_f32_16x16x32_bf16 v[28:31], a[76:79], a[92:95], v[28:31]
    v_mfma_f32_16x16x32_bf16 v[36:39], a[76:79], a[108:111], v[36:39]
    s_nop 3
    v_cvt_pk_bf16_f32 v40, v24, v25
    v_cvt_pk_bf16_f32 v41, v26, v27
    s_nop 0
    v_cvt_pk_bf16_f32 v42, v28, v29
    v_cvt_pk_bf16_f32 v43, v30, v31
    buffer_store_dwordx4 v[40:43], v10, s[32:35], s96 offen sc1
    v_cvt_pk_bf16_f32 v44, v32, v33
    v_cvt_pk_bf16_f32 v45, v34, v35
    v_cvt_pk_bf16_f32 v46, v36, v37
    v_cvt_pk_bf16_f32 v47, v38, v39
    buffer_store_dwordx4 v[44:47], v10, s[32:35], s97 offen sc1
    v_bfe_u32 v114, v1, 2, 1
    v_lshlrev_b32 v114, 4, v114
    v_bfe_u32 v115, v1, 3, 2
    v_lshl_add_u32 v114, v115, 2, v114
    v_and_b32 v115, 3, v1
    v_add_u32 v114, v114, v115
    s_lshl_b32 s49, s55, 1
    s_add_u32 m0, s58, 69632
    s_add_u32 s47, s57, 491520
    buffer_load_dwordx4 v11, s[24:27], s47 offen lds
    s_add_u32 s49, s49, s52
    s_lshl_b32 s49, s49, 5
    v_add_u32 v114, s49, v114
    v_cvt_f32_u32 v114, v114
    v_mul_f32 v118, 0x3b000000, v114
    v_lshrrev_b32 v115, 5, v1
    v_lshl_add_u32 v115, v115, 2, 1
    s_add_u32 m0, s58, 71680
    s_add_u32 s47, s57, 507904
    buffer_load_dwordx4 v11, s[24:27], s47 offen lds
    v_cvt_f32_u32 v115, v115
    v_mul_f32 v119, v115, v118
    v_mul_f32 v120, 4.0, v118
    v_and_b32 v114, 1, v1
    v_lshlrev_b32 v121, 4, v114
    v_bfe_u32 v115, v1, 1, 1
    v_and_b32 v15, 15, v1
    v_min_u32 v15, 13, v15
    v_lshlrev_b32 v15, 4, v15
    s_lshr_b32 s51, s54, 2
    s_lshl_b32 s51, s51, 8
    s_add_u32 s51, s51, 0x1111000
    buffer_load_dword v126, v15, s[32:35], s51 offen sc1
    s_add_u32 m0, s58, 81920
    s_add_u32 s47, s57, 524288
    buffer_load_dwordx4 v11, s[24:27], s47 offen lds
    s_add_u32 m0, s58, 83968
    s_add_u32 s47, s57, 540672
    buffer_load_dwordx4 v11, s[24:27], s47 offen lds
    s_add_u32 m0, s58, 86016
    s_add_u32 s47, s57, 557056
    buffer_load_dwordx4 v11, s[24:27], s47 offen lds
    s_add_u32 m0, s58, 88064
    s_add_u32 s47, s57, 573440
    buffer_load_dwordx4 v11, s[24:27], s47 offen lds
    v_xor_b32 v114, v114, v115
    v_lshlrev_b32 v114, 15, v114
    v_lshl_or_b32 v114, v115, 31, v114
    v_cos_f32 v116, v119
    v_sin_f32 v117, v119
    v_add_f32 v119, v119, v118
    v_cvt_pk_bf16_f32 v176, v116, v117
    v_alignbit_b32 v115, v176, v176, v121
    v_xor_b32 v24, v115, v114
    v_cos_f32 v116, v119
    v_sin_f32 v117, v119
    v_add_f32 v119, v119, v118
    v_cvt_pk_bf16_f32 v177, v116, v117
    v_alignbit_b32 v115, v177, v177, v121
    v_xor_b32 v25, v115, v114
    v_cos_f32 v116, v119
    v_sin_f32 v117, v119
    v_add_f32 v119, v119, v118
    v_cvt_pk_bf16_f32 v178, v116, v117
    v_alignbit_b32 v115, v178, v178, v121
    v_xor_b32 v26, v115, v114
    v_cos_f32 v116, v119
    v_sin_f32 v117, v119
    v_add_f32 v119, v119, v118
    v_cvt_pk_bf16_f32 v179, v116, v117
    v_alignbit_b32 v115, v179, v179, v121
    v_xor_b32 v27, v115, v114
    v_add_f32 v119, v119, v120
    v_cos_f32 v116, v119
    v_sin_f32 v117, v119
    v_add_f32 v119, v119, v118
    v_cvt_pk_bf16_f32 v180, v116, v117
    v_alignbit_b32 v115, v180, v180, v121
    v_xor_b32 v28, v115, v114
    v_cos_f32 v116, v119
    v_sin_f32 v117, v119
    v_add_f32 v119, v119, v118
    v_cvt_pk_bf16_f32 v181, v116, v117
    v_alignbit_b32 v115, v181, v181, v121
    v_xor_b32 v29, v115, v114
    v_cos_f32 v116, v119
    v_sin_f32 v117, v119
    v_add_f32 v119, v119, v118
    v_cvt_pk_bf16_f32 v182, v116, v117
    v_alignbit_b32 v115, v182, v182, v121
    v_xor_b32 v30, v115, v114
    v_cos_f32 v116, v119
    v_sin_f32 v117, v119
    v_add_f32 v119, v119, v118
    v_cvt_pk_bf16_f32 v183, v116, v117
    v_alignbit_b32 v115, v183, v183, v121
    v_xor_b32 v31, v115, v114
    v_add_f32 v119, v119, v120
    v_cos_f32 v116, v119
    v_sin_f32 v117, v119
    v_add_f32 v119, v119, v118
    v_cvt_pk_bf16_f32 v184, v116, v117
    v_alignbit_b32 v115, v184, v184, v121
    v_xor_b32 v32, v115, v114
    v_cos_f32 v116, v119
    v_sin_f32 v117, v119
    v_add_f32 v119, v119, v118
    v_cvt_pk_bf16_f32 v185, v116, v117
    v_alignbit_b32 v115, v185, v185, v121
    v_xor_b32 v33, v115, v114
    v_cos_f32 v116, v119
    v_sin_f32 v117, v119
    v_add_f32 v119, v119, v118
    v_cvt_pk_bf16_f32 v186, v116, v117
    v_alignbit_b32 v115, v186, v186, v121
    v_xor_b32 v34, v115, v114
    v_cos_f32 v116, v119
    v_sin_f32 v117, v119
    v_add_f32 v119, v119, v118
    v_cvt_pk_bf16_f32 v187, v116, v117
    v_alignbit_b32 v115, v187, v187, v121
    v_xor_b32 v35, v115, v114
    v_add_f32 v119, v119, v120
    v_cos_f32 v116, v119
    v_sin_f32 v117, v119
    v_add_f32 v119, v119, v118
    v_cvt_pk_bf16_f32 v188, v116, v117
    v_alignbit_b32 v115, v188, v188, v121
    v_xor_b32 v36, v115, v114
    v_cos_f32 v116, v119
    v_sin_f32 v117, v119
    v_add_f32 v119, v119, v118
    v_cvt_pk_bf16_f32 v189, v116, v117
    v_alignbit_b32 v115, v189, v189, v121
    v_xor_b32 v37, v115, v114
    v_cos_f32 v116, v119
    v_sin_f32 v117, v119
    v_add_f32 v119, v119, v118
    v_cvt_pk_bf16_f32 v190, v116, v117
    v_alignbit_b32 v115, v190, v190, v121
    v_xor_b32 v38, v115, v114
    v_cos_f32 v116, v119
    v_sin_f32 v117, v119
    v_add_f32 v119, v119, v118
    v_cvt_pk_bf16_f32 v191, v116, v117
    v_alignbit_b32 v115, v191, v191, v121
    v_xor_b32 v39, v115, v114
    v_add_f32 v119, v119, v120
    v_cos_f32 v116, v119
    v_sin_f32 v117, v119
    v_add_f32 v119, v119, v118
    v_cvt_pk_bf16_f32 v192, v116, v117
    v_alignbit_b32 v115, v192, v192, v121
    v_xor_b32 v40, v115, v114
    v_cos_f32 v116, v119
    v_sin_f32 v117, v119
    v_add_f32 v119, v119, v118
    v_cvt_pk_bf16_f32 v193, v116, v117
    v_alignbit_b32 v115, v193, v193, v121
    v_xor_b32 v41, v115, v114
    v_cos_f32 v116, v119
    v_sin_f32 v117, v119
    v_add_f32 v119, v119, v118
    v_cvt_pk_bf16_f32 v194, v116, v117
    v_alignbit_b32 v115, v194, v194, v121
    s_branch L_C
L_noB:
    s_waitcnt lgkmcnt(0)
    buffer_store_dwordx4 v[96:99], v113, s[32:35], s101 offen sc1
    s_add_u32 s101, s101, 262272
    buffer_store_dwordx4 v[100:103], v113, s[32:35], s101 offen sc1
    s_add_u32 s101, s101, 262272
    buffer_store_dwordx4 v[104:107], v113, s[32:35], s101 offen sc1
    s_add_u32 s101, s101, 262272
    buffer_store_dwordx4 v[108:111], v113, s[32:35], s101 offen sc1
    v_lshlrev_b32 v12, 7, v1
    s_sub_u32 s46, s2, 224
    s_lshl_b32 s46, s46, 2
    s_add_u32 s46, s46, s36
    s_waitcnt vmcnt(0)
    s_barrier
    s_lshl_b32 s49, s2, 2
    s_add_u32 s49, s49, 0x1109000
    s_cmp_lg_u32 s36, 0
    s_cbranch_scc1 L_f2b
    v_mov_b32 v124, s37
    v_mov_b32 v125, 0
    s_mov_b64 exec, 1
    buffer_store_dword v124, v125, s[32:35], s49 offen sc1
    s_mov_b64 exec, -1
L_f2b:
    s_sub_u32 s47, s2, 224
    s_lshl_b32 s47, s47, 2
    s_add_u32 s47, s47, s36
    s_mul_i32 s47, s47, 3584
    s_add_u32 s47, s47, 458752
    v_lshlrev_b32 v112, 7, v1
    v_mov_b32 v111, 0x7ff00000
    v_cmp_gt_u32 vcc, 28, v1
    s_nop 1
    v_cndmask_b32 v112, v111, v112, vcc
    buffer_load_dword a240, v112, s[16:19], s47 offen
    buffer_load_dword a241, v112, s[20:23], s47 offen
    s_add_u32 s47, s47, 458752
    buffer_load_dword a242, v112, s[16:19], s47 offen
    buffer_load_dword a243, v112, s[20:23], s47 offen
    s_add_u32 s47, s47, 458752
    buffer_load_dword a244, v112, s[16:19], s47 offen
    buffer_load_dword a245, v112, s[20:23], s47 offen
    s_add_u32 s47, s47, 458752
    s_mul_i32 s47, s46, 14336
    v_cmp_gt_u32 vcc, 48, v1
    v_mov_b32 v13, 0x7ff00000
    buffer_load_dword a246, v12, s[24:27], s47 offen
    v_cndmask_b32 v13, v13, v12, vcc
    s_add_u32 s47, s47, 8192
    buffer_load_dword a247, v13, s[24:27], s47 offen
    v_sin_f32 v115, v115
    v_cvt_pk_bf16_f32 v27, v116, v117
    v_cvt_pk_bf16_f32 v43, -v114, -v115
    v_and_b32 v114, 1, v1
    v_cmp_eq_u32 vcc, 1, v114
    v_mul_u32_u24 v119, 0x8000, v114
    v_lshl_or_b32 v119, v119, 16, v119
    v_bfe_u32 v115, v1, 1, 1
    v_mul_u32_u24 v120, 0x8000, v115
    v_lshl_or_b32 v120, v120, 16, v120
    v_xor_b32 v121, v119, v120
    v_cndmask_b32 v116, v24, v40, vcc
    v_cndmask_b32 v117, v40, v24, vcc
    v_xor_b32 v28, v116, v120
    v_xor_b32 v44, v117, v121
    v_cndmask_b32 v116, v25, v41, vcc
    v_cndmask_b32 v117, v41, v25, vcc
    v_xor_b32 v29, v116, v120
    v_xor_b32 v45, v117, v121
    v_cndmask_b32 v116, v26, v42, vcc
    v_cndmask_b32 v117, v42, v26, vcc
    v_xor_b32 v30, v116, v120
    v_xor_b32 v46, v117, v121
    v_cndmask_b32 v116, v27, v43, vcc
    v_cndmask_b32 v117, v43, v27, vcc
    v_xor_b32 v31, v116, v120
    v_xor_b32 v47, v117, v121
    v_xor_b32 v32, v24, v119
    v_xor_b32 v48, v40, v119
    v_xor_b32 v33, v25, v119
    v_xor_b32 v49, v41, v119
    v_xor_b32 v34, v26, v119
    v_xor_b32 v50, v42, v119
    v_xor_b32 v35, v27, v119
    v_xor_b32 v51, v43, v119
    v_xor_b32 v36, v28, v119
    v_xor_b32 v52, v44, v119
    v_xor_b32 v37, v29, v119
    v_xor_b32 v53, v45, v119
    v_xor_b32 v38, v30, v119
    v_xor_b32 v54, v46, v119
    v_xor_b32 v39, v31, v119
    v_xor_b32 v55, v47, v119
    v_accvgpr_write_b32 a80, v24
    v_accvgpr_write_b32 a81, v25
    v_accvgpr_write_b32 a82, v26
    v_accvgpr_write_b32 a83, v27
    v_accvgpr_write_b32 a84, v28
    v_accvgpr_write_b32 a85, v29
    v_accvgpr_write_b32 a86, v30
    v_accvgpr_write_b32 a87, v31
    v_accvgpr_write_b32 a88, v32
    v_accvgpr_write_b32 a89, v33
    v_accvgpr_write_b32 a90, v34
    v_accvgpr_write_b32 a91, v35
    v_accvgpr_write_b32 a92, v36
    v_accvgpr_write_b32 a93, v37
    v_accvgpr_write_b32 a94, v38
    v_accvgpr_write_b32 a95, v39
    v_accvgpr_write_b32 a96, v40
    v_accvgpr_write_b32 a97, v41
    v_accvgpr_write_b32 a98, v42
    v_accvgpr_write_b32 a99, v43
    v_accvgpr_write_b32 a100, v44
    v_accvgpr_write_b32 a101, v45
    v_accvgpr_write_b32 a102, v46
    v_accvgpr_write_b32 a103, v47
    v_accvgpr_write_b32 a104, v48
    v_accvgpr_write_b32 a105, v49
    v_accvgpr_write_b32 a106, v50
    v_accvgpr_write_b32 a107, v51
    v_accvgpr_write_b32 a108, v52
    v_accvgpr_write_b32 a109, v53
    v_accvgpr_write_b32 a110, v54
    v_accvgpr_write_b32 a111, v55
    v_and_b32 v11, 31, v1
    v_lshrrev_b32 v12, 5, v1
    v_bfe_u32 v13, v1, 1, 3
    v_or_b32 v14, 0, v12
    v_xor_b32 v14, v14, v13
    v_lshlrev_b32 v14, 4, v14
    v_lshl_add_u32 v2, v11, 7, v14
    v_or_b32 v14, 2, v12
    v_xor_b32 v14, v14, v13
    v_lshlrev_b32 v14, 4, v14
    v_lshl_add_u32 v3, v11, 7, v14
    v_or_b32 v14, 4, v12
    v_xor_b32 v14, v14, v13
    v_lshlrev_b32 v14, 4, v14
    v_lshl_add_u32 v4, v11, 7, v14
    v_or_b32 v14, 6, v12
    v_xor_b32 v14, v14, v13
    v_lshlrev_b32 v14, 4, v14
    v_lshl_add_u32 v5, v11, 7, v14
    v_lshlrev_b32 v14, 11, v12
    v_bfe_u32 v13, v1, 2, 2
    v_lshl_add_u32 v14, v13, 8, v14
    v_xor_b32 v13, s36, v13
    v_lshl_add_u32 v14, v13, 6, v14
    v_bfe_u32 v13, v1, 4, 1
    v_lshl_add_u32 v14, v13, 5, v14
    v_and_b32 v13, 1, v1
    v_lshl_add_u32 v14, v13, 4, v14
    v_bfe_u32 v13, v1, 1, 1
    v_lshl_add_u32 v6, v13, 3, v14
    v_lshlrev_b32 v12, 2, v1
    v_and_b32 v12, 64, v12
    v_xor_b32 v12, v12, v10
    v_and_b32 v12, 127, v12
    v_lshrrev_b32 v13, 3, v1
    v_lshl_add_u32 v11, v13, 10, v12
    s_and_b32 s48, s36, 1
    s_mul_i32 s57, s48, 917504
    s_lshl_b32 s58, s48, 13
    s_bfe_u32 s48, s2, 0x30003
    s_lshl_b32 s48, s48, 7
    s_add_u32 s57, s57, s48
    s_lshr_b32 s48, s36, 1
    s_lshl_b32 s48, s48, 13
    s_add_u32 s57, s57, s48
    s_lshr_b32 s48, s48, 3
    s_add_u32 s58, s58, s48
    v_lshrrev_b32 v12, 5, v1
    v_lshlrev_b32 v16, 10, v12
    v_bfe_u32 v12, v1, 2, 2
    v_lshl_add_u32 v16, v12, 7, v16
    v_bfe_u32 v12, v1, 3, 1
    v_lshl_add_u32 v16, v12, 6, v16
    v_mov_b32 v22, v16
    v_bfe_u32 v12, v1, 4, 1
    v_lshl_add_u32 v16, v12, 4, v16
    v_and_b32 v12, 1, v1
    v_lshl_add_u32 v16, v12, 5, v16
    v_bfe_u32 v12, v1, 1, 1
    v_lshl_add_u32 v16, v12, 3, v16
    s_and_b32 s48, s36, 1
    s_mul_i32 s48, s48, 8256
    v_xor_b32 v16, s48, v16
    v_xor_b32 v17, 64, v16
    v_add_u32 v18, 0x10000, v16
    v_add_u32 v19, 0x10000, v17
    v_add_u32 v20, 0x20000, v16
    v_add_u32 v21, 0x20000, v17
    s_and_b32 s48, s2, 7
    s_lshl_b32 s48, s48, 2
    s_lshr_b32 s49, s2, 6
    s_add_u32 s48, s48, s49
    s_bfe_u32 s55, s2, 0x30003
    s_and_b32 s52, s36, 1
    s_lshr_b32 s53, s36, 1
    s_lshl_b32 s48, s48, 1
    s_add_u32 s54, s48, s53
    v_lshrrev_b32 v12, 4, v1
    v_xor_b32 v12, v12, v1
    v_and_b32 v12, 3, v12
    v_lshlrev_b32 v12, 4, v12
    v_lshrrev_b32 v13, 2, v1
    v_and_b32 v13, 1, v13
    v_lshl_add_u32 v12, v13, 6, v12
    v_lshrrev_b32 v13, 3, v1
    v_lshl_add_u32 v13, v13, 11, v12
    v_lshrrev_b32 v12, 5, v1
    v_lshlrev_b32 v127, 11, v12
    v_lshlrev_b32 v123, 9, v12
    v_bfe_u32 v12, v1, 2, 2
    v_lshl_add_u32 v127, v12, 9, v127
    v_and_b32 v12, 3, v1
    v_lshl_add_u32 v127, v12, 6, v127
    v_bfe_u32 v12, v1, 4, 1
    v_lshl_add_u32 v123, v12, 12, v123
    v_bfe_u32 v14, v1, 2, 1
    v_lshl_add_u32 v12, v14, 1, v12
    v_lshl_add_u32 v127, v12, 4, v127
    v_and_b32 v12, 15, v1
    v_lshl_add_u32 v123, v12, 4, v123
    v_lshlrev_b32 v122, 6, v12
    v_lshrrev_b32 v14, 2, v12
    v_xor_b32 v14, 2, v14
    v_lshl_add_u32 v14, v14, 4, v122
    v_lshrrev_b32 v12, 4, v1
    v_lshl_add_u32 v14, v12, 12, v14
    v_bfe_u32 v23, v1, 1, 2
    v_xor_b32 v23, v23, v12
    v_lshl_add_u32 v122, v23, 4, v122
    s_lshl_b32 s96, s36, 10
    s_add_u32 s96, s96, 147456
    v_add_u32 v122, s96, v122
    v_add_u32 v14, s96, v14
    v_add_u32 v127, 147456, v127
    v_add_u32 v123, 147456, v123
    v_bfe_u32 v23, v1, 3, 1
    v_lshlrev_b32 v23, 4, v23
    v_xor_b32 v123, v123, v23
    v_xor_b32 v23, 32, v123
    s_lshr_b32 s96, s45, 8
    s_mul_i32 s96, s96, 262272
    s_and_b32 s97, s45, 255
    s_lshl_b32 s97, s97, 3
    s_add_u32 s96, s96, s97
    s_lshl_b32 s97, s36, 16
    s_add_u32 s96, s96, s97
    s_add_u32 s96, s96, 0xa00000
    v_mul_f32 v119, 0x3a000000, v118
    v_lshrrev_b32 v120, 4, v1
    v_cvt_f32_u32 v120, v120
    v_mul_f32 v120, 0x41000000, v120
    v_mul_f32 v114, v120, v119
    v_cos_f32 v80, v114
    v_sin_f32 v88, v114
    v_add_f32 v114, v114, v119
    v_cos_f32 v81, v114
    v_sin_f32 v89, v114
    v_add_f32 v114, v114, v119
    v_cos_f32 v82, v114
    v_sin_f32 v90, v114
    v_add_f32 v114, v114, v119
    v_cos_f32 v83, v114
    v_sin_f32 v91, v114
    v_add_f32 v114, v114, v119
    v_cos_f32 v84, v114
    v_sin_f32 v92, v114
    v_add_f32 v114, v114, v119
    v_cos_f32 v85, v114
    v_sin_f32 v93, v114
    v_add_f32 v114, v114, v119
    v_cos_f32 v86, v114
    v_sin_f32 v94, v114
    v_add_f32 v114, v114, v119
    v_cos_f32 v87, v114
    v_sin_f32 v95, v114
    v_bfe_u32 v114, v1, 2, 2
    v_and_b32 v115, 3, v1
    v_lshl_add_u32 v114, v114, 3, v115
    v_cvt_f32_u32 v118, v114
    v_add_f32 v119, 0x0, v118
    v_mul_f32 v119, 0x3d000000, v119
    v_mul_f32 v121, v120, v119
    v_add_f32 v115, v121, v119
    v_cos_f32 v116, v121
    v_cos_f32 v117, v115
    v_sin_f32 v114, v121
    v_add_f32 v121, v115, v119
    v_sin_f32 v115, v115
    v_cvt_pk_bf16_f32 v116, v116, v117
    v_cvt_pk_bf16_f32 v117, -v114, -v115
    v_cvt_pk_bf16_f32 v114, v114, v115
    v_accvgpr_write_b32 a112, v116
    v_accvgpr_write_b32 a128, v117
    v_accvgpr_write_b32 a120, v114
    v_add_f32 v115, v121, v119
    v_cos_f32 v116, v121
    v_cos_f32 v117, v115
    v_sin_f32 v114, v121
    v_add_f32 v121, v115, v119
    v_sin_f32 v115, v115
    v_cvt_pk_bf16_f32 v116, v116, v117
    v_cvt_pk_bf16_f32 v117, -v114, -v115
    v_cvt_pk_bf16_f32 v114, v114, v115
    v_accvgpr_write_b32 a113, v116
    v_accvgpr_write_b32 a129, v117
    v_accvgpr_write_b32 a121, v114
    v_add_f32 v115, v121, v119
    v_cos_f32 v116, v121
    v_cos_f32 v117, v115
    v_sin_f32 v114, v121
    v_add_f32 v121, v115, v119
    v_sin_f32 v115, v115
    v_cvt_pk_bf16_f32 v116, v116, v117
    v_cvt_pk_bf16_f32 v117, -v114, -v115
    v_cvt_pk_bf16_f32 v114, v114, v115
    v_accvgpr_write_b32 a114, v116
    v_accvgpr_write_b32 a130, v117
    v_accvgpr_write_b32 a122, v114
    v_add_f32 v115, v121, v119
    v_cos_f32 v116, v121
    v_cos_f32 v117, v115
    v_sin_f32 v114, v121
    v_add_f32 v121, v115, v119
    v_sin_f32 v115, v115
    v_cvt_pk_bf16_f32 v116, v116, v117
    v_cvt_pk_bf16_f32 v117, -v114, -v115
    v_cvt_pk_bf16_f32 v114, v114, v115
    v_accvgpr_write_b32 a115, v116
    v_accvgpr_write_b32 a131, v117
    v_accvgpr_write_b32 a123, v114
    v_add_f32 v119, 0x40800000, v118
    v_mul_f32 v119, 0x3d000000, v119
    v_mul_f32 v121, v120, v119
    v_add_f32 v115, v121, v119
    v_cos_f32 v116, v121
    v_cos_f32 v117, v115
    v_sin_f32 v114, v121
    v_add_f32 v121, v115, v119
    v_sin_f32 v115, v115
    v_cvt_pk_bf16_f32 v116, v116, v117
    v_cvt_pk_bf16_f32 v117, -v114, -v115
    v_cvt_pk_bf16_f32 v114, v114, v115
    v_accvgpr_write_b32 a116, v116
    v_accvgpr_write_b32 a132, v117
    v_accvgpr_write_b32 a124, v114
    v_add_f32 v115, v121, v119
    v_cos_f32 v116, v121
    v_cos_f32 v117, v115
    v_sin_f32 v114, v121
    v_add_f32 v121, v115, v119
    v_sin_f32 v115, v115
    v_cvt_pk_bf16_f32 v116, v116, v117
    v_cvt_pk_bf16_f32 v117, -v114, -v115
    v_cvt_pk_bf16_f32 v114, v114, v115
    v_accvgpr_write_b32 a117, v116
    v_accvgpr_write_b32 a133, v117
    v_accvgpr_write_b32 a125, v114
    v_add_f32 v115, v121, v119
    v_cos_f32 v116, v121
    v_cos_f32 v117, v115
    v_sin_f32 v114, v121
    v_add_f32 v121, v115, v119
    v_sin_f32 v115, v115
    v_cvt_pk_bf16_f32 v116, v116, v117
    v_cvt_pk_bf16_f32 v117, -v114, -v115
    v_cvt_pk_bf16_f32 v114, v114, v115
    v_accvgpr_write_b32 a118, v116
    v_accvgpr_write_b32 a134, v117
    v_accvgpr_write_b32 a126, v114
    v_add_f32 v115, v121, v119
    v_cos_f32 v116, v121
    v_cos_f32 v117, v115
    v_sin_f32 v114, v121
    v_add_f32 v121, v115, v119
    v_sin_f32 v115, v115
    v_cvt_pk_bf16_f32 v116, v116, v117
    v_cvt_pk_bf16_f32 v117, -v114, -v115
    v_cvt_pk_bf16_f32 v114, v114, v115
    v_accvgpr_write_b32 a119, v116
    v_accvgpr_write_b32 a135, v117
    v_accvgpr_write_b32 a127, v114
    v_lshlrev_b32 v15, 2, v1
    s_lshl_b32 s51, s36, 8
    s_add_u32 s51, s51, 0x1109000
    buffer_load_dword v126, v15, s[32:35], s51 offen sc1
    s_waitcnt vmcnt(0)
    v_cmp_ne_u32 vcc, s37, v126
    s_nop 1
    s_cbranch_vccnz L_s2b_spin
L_s2b_ok:
    s_barrier
    s_lshl_b32 m0, s36, 12
    s_add_u32 m0, m0, 147456
    s_nop 0
    buffer_load_dwordx4 v13, s[32:35], s96 offen sc1 lds
    s_add_u32 s96, s96, 16384
    s_lshl_b32 m0, s36, 12
    s_add_u32 m0, m0, 148480
    s_nop 0
    buffer_load_dwordx4 v13, s[32:35], s96 offen sc1 lds
    s_add_u32 s96, s96, 16384
    s_lshl_b32 m0, s36, 12
    s_add_u32 m0, m0, 149504
    s_nop 0
    buffer_load_dwordx4 v13, s[32:35], s96 offen sc1 lds
    s_add_u32 s96, s96, 16384
    s_lshl_b32 m0, s36, 12
    s_add_u32 m0, m0, 150528
    s_nop 0
    buffer_load_dwordx4 v13, s[32:35], s96 offen sc1 lds
    s_waitcnt vmcnt(0)
    s_barrier
    v_xor_b32 v72, 16, v127
    v_xor_b32 v73, 16, v14
    ds_read_b128 a[48:51], v127 offset:0
    ds_read_b128 a[64:67], v72 offset:256
    ds_read_b128 a[52:55], v127 offset:4096
    ds_read_b128 a[68:71], v72 offset:4352
    ds_read_b128 a[56:59], v127 offset:8192
    ds_read_b128 a[72:75], v72 offset:8448
    ds_read_b128 a[60:63], v127 offset:12288
    ds_read_b128 a[76:79], v72 offset:12544
    ds_read_b128 v[64:67], v14
    ds_read_b128 v[68:71], v73
    s_waitcnt lgkmcnt(0)
    s_barrier
    v_mfma_f32_16x16x32_bf16 v[24:27], a[48:51], a[80:83], 0
    v_lshlrev_b32 v48, 16, v64
    v_mfma_f32_16x16x32_bf16 v[32:35], a[48:51], a[96:99], 0
    v_and_b32 v49, 0xffff0000, v64
    v_mfma_f32_16x16x32_bf16 v[28:31], a[64:67], a[80:83], 0
    v_lshlrev_b32 v50, 16, v65
    v_mfma_f32_16x16x32_bf16 v[36:39], a[64:67], a[96:99], 0
    v_and_b32 v51, 0xffff0000, v65
    v_mfma_f32_16x16x32_bf16 v[24:27], a[52:55], a[84:87], v[24:27]
    v_lshlrev_b32 v52, 16, v66
    v_mfma_f32_16x16x32_bf16 v[32:35], a[52:55], a[100:103], v[32:35]
    v_and_b32 v53, 0xffff0000, v66
    v_mfma_f32_16x16x32_bf16 v[28:31], a[68:71], a[84:87], v[28:31]
    v_lshlrev_b32 v54, 16, v67
    v_mfma_f32_16x16x32_bf16 v[36:39], a[68:71], a[100:103], v[36:39]
    v_and_b32 v55, 0xffff0000, v67
    v_mfma_f32_16x16x32_bf16 v[24:27], a[56:59], a[88:91], v[24:27]
    v_lshlrev_b32 v56, 16, v68
    v_mfma_f32_16x16x32_bf16 v[32:35], a[56:59], a[104:107], v[32:35]
    v_and_b32 v57, 0xffff0000, v68
    v_mfma_f32_16x16x32_bf16 v[28:31], a[72:75], a[88:91], v[28:31]
    v_lshlrev_b32 v58, 16, v69
    v_mfma_f32_16x16x32_bf16 v[36:39], a[72:75], a[104:107], v[36:39]
    v_and_b32 v59, 0xffff0000, v69
    v_mfma_f32_16x16x32_bf16 v[24:27], a[60:63], a[92:95], v[24:27]
    v_lshlrev_b32 v60, 16, v70
    v_mfma_f32_16x16x32_bf16 v[32:35], a[60:63], a[108:111], v[32:35]
    v_and_b32 v61, 0xffff0000, v70
    v_mfma_f32_16x16x32_bf16 v[28:31], a[76:79], a[92:95], v[28:31]
    v_lshlrev_b32 v62, 16, v71
    v_mfma_f32_16x16x32_bf16 v[36:39], a[76:79], a[108:111], v[36:39]
    v_and_b32 v63, 0xffff0000, v71
    s_nop 0
    v_pk_mul_f32 v[72:73], v[24:25], v[80:81]
    s_nop 0
    v_pk_mul_f32 v[74:75], v[32:33], v[80:81]
    v_pk_fma_f32 v[72:73], v[32:33], v[88:89], v[72:73]
    v_pk_fma_f32 v[74:75], v[24:25], v[88:89], v[74:75] neg_lo:[1,0,0] neg_hi:[1,0,0]
    v_cvt_pk_bf16_f32 v40, v72, v73
    v_cvt_pk_bf16_f32 v44, v74, v75
    v_pk_mul_f32 v[76:77], v[26:27], v[82:83]
    v_pk_mul_f32 v[78:79], v[34:35], v[82:83]
    v_pk_fma_f32 v[76:77], v[34:35], v[90:91], v[76:77]
    v_pk_fma_f32 v[78:79], v[26:27], v[90:91], v[78:79] neg_lo:[1,0,0] neg_hi:[1,0,0]
    v_cvt_pk_bf16_f32 v41, v76, v77
    v_cvt_pk_bf16_f32 v45, v78, v79
    v_pk_mul_f32 v[72:73], v[28:29], v[84:85]
    v_pk_mul_f32 v[74:75], v[36:37], v[84:85]
    v_pk_fma_f32 v[72:73], v[36:37], v[92:93], v[72:73]
    v_pk_fma_f32 v[74:75], v[28:29], v[92:93], v[74:75] neg_lo:[1,0,0] neg_hi:[1,0,0]
    v_cvt_pk_bf16_f32 v42, v72, v73
    v_cvt_pk_bf16_f32 v46, v74, v75
    v_pk_mul_f32 v[76:77], v[30:31], v[86:87]
    v_pk_mul_f32 v[78:79], v[38:39], v[86:87]
    v_pk_fma_f32 v[76:77], v[38:39], v[94:95], v[76:77]
    v_pk_fma_f32 v[78:79], v[30:31], v[94:95], v[78:79] neg_lo:[1,0,0] neg_hi:[1,0,0]
    v_cvt_pk_bf16_f32 v43, v76, v77
    v_cvt_pk_bf16_f32 v47, v78, v79
    s_nop 0
    v_mfma_f32_16x16x32_bf16 v[24:27], a[112:115], v[40:43], 0
    v_mfma_f32_16x16x32_bf16 v[32:35], a[112:115], v[44:47], 0
    v_mfma_f32_16x16x32_bf16 v[28:31], a[116:119], v[40:43], 0
    v_mfma_f32_16x16x32_bf16 v[36:39], a[116:119], v[44:47], 0
    v_mfma_f32_16x16x32_bf16 v[24:27], a[120:123], v[44:47], v[24:27]
    v_mfma_f32_16x16x32_bf16 v[32:35], a[128:131], v[40:43], v[32:35]
    v_mfma_f32_16x16x32_bf16 v[28:31], a[124:127], v[44:47], v[28:31]
    v_mfma_f32_16x16x32_bf16 v[36:39], a[132:135], v[40:43], v[36:39]
    s_mul_i32 s96, s45, 528
    s_lshl_b32 s97, s36, 10
    s_add_u32 s96, s96, s97
    s_add_u32 s96, s96, 0xe40000
    s_add_u32 s97, s96, 4224
    v_and_b32 v96, 127, v11
    v_lshrrev_b32 v97, 3, v1
    v_mul_u32_u24 v9, 4224, v97
    v_add_u32 v9, v9, v96
    s_mul_i32 s56, s54, 114688
    s_mul_i32 s46, s52, 57344
    s_add_u32 s56, s56, s46
    s_lshr_b32 s59, s54, 4
    s_lshl_b32 s59, s59, 10
    s_bfe_u32 s46, s54, 0x20001
    s_lshl_b32 s48, s46, 8
    s_add_u32 s59, s59, s48
    s_lshl_b32 s38, s46, 13
    s_bfe_u32 s46, s54, 0x10003
    s_lshl_b32 s46, s46, 7
    s_add_u32 s59, s59, s46
    s_mul_i32 s46, s36, 135168
    s_add_u32 s59, s59, s46
    s_add_u32 s59, s59, 0xe40000
    s_lshr_b32 s46, s54, 3
    s_lshl_b32 s46, s46, 18
    s_add_u32 s38, s38, s46
    s_lshl_b32 s46, s36, 16
    s_add_u32 s38, s38, s46
    s_lshl_b32 s46, s55, 7
    s_add_u32 s38, s38, s46
    v_lshrrev_b32 v96, 4, v1
    v_xor_b32 v96, v96, v1
    v_and_b32 v96, 7, v96
    v_lshlrev_b32 v96, 4, v96
    v_pk_mul_f32 v[72:73], v[24:25], v[48:49]
    v_pk_mul_f32 v[74:75], v[32:33], v[48:49]
    v_pk_fma_f32 v[72:73], v[32:33], v[56:57], v[72:73] neg_lo:[1,0,0] neg_hi:[1,0,0]
    v_pk_fma_f32 v[74:75], v[24:25], v[56:57], v[74:75]
    v_cvt_pk_bf16_f32 v40, v72, v73
    v_cvt_pk_bf16_f32 v44, -v74, -v75
    v_pk_mul_f32 v[76:77], v[26:27], v[50:51]
    v_pk_mul_f32 v[78:79], v[34:35], v[50:51]
    v_pk_fma_f32 v[76:77], v[34:35], v[58:59], v[76:77] neg_lo:[1,0,0] neg_hi:[1,0,0]
    v_pk_fma_f32 v[78:79], v[26:27], v[58:59], v[78:79]
    v_cvt_pk_bf16_f32 v41, v76, v77
    v_cvt_pk_bf16_f32 v45, -v78, -v79
    v_pk_mul_f32 v[72:73], v[28:29], v[52:53]
    v_pk_mul_f32 v[74:75], v[36:37], v[52:53]
    v_pk_fma_f32 v[72:73], v[36:37], v[60:61], v[72:73] neg_lo:[1,0,0] neg_hi:[1,0,0]
    v_pk_fma_f32 v[74:75], v[28:29], v[60:61], v[74:75]
    v_cvt_pk_bf16_f32 v42, v72, v73
    v_cvt_pk_bf16_f32 v46, -v74, -v75
    v_pk_mul_f32 v[76:77], v[30:31], v[54:55]
    v_pk_mul_f32 v[78:79], v[38:39], v[54:55]
    v_pk_fma_f32 v[76:77], v[38:39], v[62:63], v[76:77] neg_lo:[1,0,0] neg_hi:[1,0,0]
    v_pk_fma_f32 v[78:79], v[30:31], v[62:63], v[78:79]
    v_cvt_pk_bf16_f32 v43, v76, v77
    v_cvt_pk_bf16_f32 v47, -v78, -v79
    s_nop 0
    v_mfma_f32_16x16x32_bf16 v[24:27], a[112:115], v[40:43], 0
    v_mfma_f32_16x16x32_bf16 v[32:35], a[112:115], v[44:47], 0
    v_mfma_f32_16x16x32_bf16 v[28:31], a[116:119], v[40:43], 0
    v_mfma_f32_16x16x32_bf16 v[36:39], a[116:119], v[44:47], 0
    v_mfma_f32_16x16x32_bf16 v[24:27], a[120:123], v[44:47], v[24:27]
    v_mfma_f32_16x16x32_bf16 v[32:35], a[128:131], v[40:43], v[32:35]
    v_mfma_f32_16x16x32_bf16 v[28:31], a[124:127], v[44:47], v[28:31]
    v_mfma_f32_16x16x32_bf16 v[36:39], a[132:135], v[40:43], v[36:39]
    v_lshl_add_u32 v12, v97, 10, v96
    v_xor_b32 v7, 64, v12
    v_bfe_u32 v96, v1, 4, 1
    v_lshl_add_u32 v8, v96, 5, v22
    v_and_b32 v96, 3, v1
    v_lshl_add_u32 v8, v96, 3, v8
    s_lshl_b32 s46, s53, 6
    s_add_u32 s46, s46, 16384
    v_xor_b32 v8, s46, v8
    v_lshrrev_b32 v96, 5, v1
    v_lshlrev_b32 v96, 1, v96
    v_bfe_u32 v97, v1, 1, 3
    v_xor_b32 v96, v96, v97
    v_lshlrev_b32 v96, 4, v96
    v_and_b32 v97, 31, v1
    v_lshl_add_u32 v96, v97, 7, v96
    s_lshl_b32 s46, s53, 12
    s_lshl_b32 s48, s52, 6
    s_add_u32 s46, s46, s48
    v_xor_b32 v96, s46, v96
    v_add_u32 v14, 81920, v96
    s_lshl_b32 s46, s36, 12
    s_add_u32 s46, s46, 147456
    v_add_u32 v13, s46, v10
    v_pk_mul_f32 v[72:73], v[24:25], v[80:81]
    v_pk_mul_f32 v[74:75], v[32:33], v[80:81]
    v_pk_fma_f32 v[72:73], v[32:33], v[88:89], v[72:73]
    v_pk_fma_f32 v[74:75], v[24:25], v[88:89], v[74:75] neg_lo:[1,0,0] neg_hi:[1,0,0]
    v_cvt_pk_bf16_f32 v40, v72, v73
    v_cvt_pk_bf16_f32 v44, v74, v75
    v_pk_mul_f32 v[76:77], v[26:27], v[82:83]
    v_pk_mul_f32 v[78:79], v[34:35], v[82:83]
    v_pk_fma_f32 v[76:77], v[34:35], v[90:91], v[76:77]
    v_pk_fma_f32 v[78:79], v[26:27], v[90:91], v[78:79] neg_lo:[1,0,0] neg_hi:[1,0,0]
    v_cvt_pk_bf16_f32 v41, v76, v77
    v_cvt_pk_bf16_f32 v45, v78, v79
    v_pk_mul_f32 v[72:73], v[28:29], v[84:85]
    v_pk_mul_f32 v[74:75], v[36:37], v[84:85]
    v_pk_fma_f32 v[72:73], v[36:37], v[92:93], v[72:73]
    v_pk_fma_f32 v[74:75], v[28:29], v[92:93], v[74:75] neg_lo:[1,0,0] neg_hi:[1,0,0]
    v_cvt_pk_bf16_f32 v42, v72, v73
    v_cvt_pk_bf16_f32 v46, v74, v75
    v_pk_mul_f32 v[76:77], v[30:31], v[86:87]
    v_pk_mul_f32 v[78:79], v[38:39], v[86:87]
    v_pk_fma_f32 v[76:77], v[38:39], v[94:95], v[76:77]
    v_pk_fma_f32 v[78:79], v[30:31], v[94:95], v[78:79] neg_lo:[1,0,0] neg_hi:[1,0,0]
    v_cvt_pk_bf16_f32 v43, v76, v77
    v_cvt_pk_bf16_f32 v47, v78, v79
    ds_write_b128 v122, v[40:43]
    ds_write_b128 v122, v[44:47] offset:4096
    s_waitcnt lgkmcnt(0)
    s_barrier
    ds_read_b64_tr_b16 a[48:49], v123 offset:0
    ds_read_b64_tr_b16 a[50:51], v23 offset:256
    ds_read_b64_tr_b16 a[64:65], v123 offset:8
    ds_read_b64_tr_b16 a[66:67], v23 offset:264
    ds_read_b64_tr_b16 a[52:53], v123 offset:1024
    ds_read_b64_tr_b16 a[54:55], v23 offset:1280
    ds_read_b64_tr_b16 a[68:69], v123 offset:1032
    ds_read_b64_tr_b16 a[70:71], v23 offset:1288
    ds_read_b64_tr_b16 a[56:57], v123 offset:2048
    ds_read_b64_tr_b16 a[58:59], v23 offset:2304
    ds_read_b64_tr_b16 a[72:73], v123 offset:2056
    ds_read_b64_tr_b16 a[74:75], v23 offset:2312
    ds_read_b64_tr_b16 a[60:61], v123 offset:3072
    ds_read_b64_tr_b16 a[62:63], v23 offset:3328
    ds_read_b64_tr_b16 a[76:77], v123 offset:3080
    ds_read_b64_tr_b16 a[78:79], v23 offset:3336
    s_waitcnt lgkmcnt(14)
    v_mfma_f32_16x16x32_bf16 v[24:27], a[48:51], a[80:83], 0
    v_mfma_f32_16x16x32_bf16 v[32:35], a[48:51], a[96:99], 0
    s_waitcnt lgkmcnt(12)
    v_mfma_f32_16x16x32_bf16 v[28:31], a[64:67], a[80:83], 0
    v_mfma_f32_16x16x32_bf16 v[36:39], a[64:67], a[96:99], 0
    s_waitcnt lgkmcnt(10)
    v_mfma_f32_16x16x32_bf16 v[24:27], a[52:55], a[84:87], v[24:27]
    v_mfma_f32_16x16x32_bf16 v[32:35], a[52:55], a[100:103], v[32:35]
    s_waitcnt lgkmcnt(8)
    v_mfma_f32_16x16x32_bf16 v[28:31], a[68:71], a[84:87], v[28:31]
    v_mfma_f32_16x16x32_bf16 v[36:39], a[68:71], a[100:103], v[36:39]
    s_waitcnt lgkmcnt(6)
    v_mfma_f32_16x16x32_bf16 v[24:27], a[56:59], a[88:91], v[24:27]
    v_mfma_f32_16x16x32_bf16 v[32:35], a[56:59], a[104:107], v[32:35]
    s_waitcnt lgkmcnt(4)
    v_mfma_f32_16x16x32_bf16 v[28:31], a[72:75], a[88:91], v[28:31]
    v_mfma_f32_16x16x32_bf16 v[36:39], a[72:75], a[104:107], v[36:39]
    s_waitcnt lgkmcnt(2)
    v_mfma_f32_16x16x32_bf16 v[24:27], a[60:63], a[92:95], v[24:27]
    v_mfma_f32_16x16x32_bf16 v[32:35], a[60:63], a[108:111], v[32:35]
    s_waitcnt lgkmcnt(0)
    v_mfma_f32_16x16x32_bf16 v[28:31], a[76:79], a[92:95], v[28:31]
    v_mfma_f32_16x16x32_bf16 v[36:39], a[76:79], a[108:111], v[36:39]
    s_nop 3
    v_cvt_pk_bf16_f32 v40, v24, v25
    v_cvt_pk_bf16_f32 v41, v26, v27
    s_nop 0
    v_cvt_pk_bf16_f32 v42, v28, v29
    v_cvt_pk_bf16_f32 v43, v30, v31
    buffer_store_dwordx4 v[40:43], v10, s[32:35], s96 offen sc1
    v_cvt_pk_bf16_f32 v44, v32, v33
    v_cvt_pk_bf16_f32 v45, v34, v35
    v_cvt_pk_bf16_f32 v46, v36, v37
    v_cvt_pk_bf16_f32 v47, v38, v39
    buffer_store_dwordx4 v[44:47], v10, s[32:35], s97 offen sc1
    v_lshlrev_b32 v6, 7, v1
    s_lshl_b32 s44, s2, 3
    s_add_u32 s44, s44, 0x1119000
    s_waitcnt vmcnt(0)
    s_barrier
    s_cmp_lg_u32 s36, 0
    s_cbranch_scc1 L_f4b
    v_mov_b32 v124, s37
    v_mov_b32 v125, 0
    s_mov_b64 exec, 1
    buffer_store_dword v124, v125, s[32:35], s44 offen sc1
    s_mov_b64 exec, -1
L_f4b:
    s_lshr_b32 s46, s2, 3
    s_sub_u32 s46, s46, 28
    s_lshl_b32 s46, s46, 2
    s_add_u32 s46, s46, s36
    s_lshr_b32 s47, s46, 3
    s_mul_i32 s47, s47, 917504
    s_and_b32 s46, s46, 7
    s_lshl_b32 s46, s46, 13
    s_add_u32 s46, s46, s47
    s_add_u32 s46, s46, 0
    v_lshlrev_b32 v6, 7, v1
    buffer_load_dword a240, v6, s[24:27], s46 offen
    s_add_u32 s46, s46, 65536
    buffer_load_dword a241, v6, s[24:27], s46 offen
    s_add_u32 s46, s46, 65536
    buffer_load_dword a242, v6, s[24:27], s46 offen
    s_add_u32 s46, s46, 65536
    buffer_load_dword a243, v6, s[24:27], s46 offen
    s_add_u32 s46, s46, 65536
    buffer_load_dword a244, v6, s[24:27], s46 offen
    s_add_u32 s46, s46, 65536
    buffer_load_dword a245, v6, s[24:27], s46 offen
    s_add_u32 s46, s46, 65536
    s_add_u32 m0, s58, 0
    s_add_u32 s47, s57, 851968
    buffer_load_dwordx4 v11, s[24:27], s47 offen lds
    s_add_u32 m0, s58, 2048
    s_add_u32 s47, s57, 868352
    buffer_load_dwordx4 v11, s[24:27], s47 offen lds
    s_add_u32 m0, s58, 4096
    s_add_u32 s47, s57, 884736
    buffer_load_dwordx4 v11, s[24:27], s47 offen lds
    s_add_u32 m0, s58, 6144
    s_add_u32 s47, s57, 901120
    buffer_load_dwordx4 v11, s[24:27], s47 offen lds
    s_waitcnt vmcnt(0)
    s_barrier
    ds_read_b64_tr_b16 a[136:137], v16 offset:0
    ds_read_b64_tr_b16 a[138:139], v16 offset:512
    ds_read_b64_tr_b16 a[140:141], v17 offset:0
    ds_read_b64_tr_b16 a[142:143], v17 offset:512
    ds_read_b64_tr_b16 a[144:145], v16 offset:2048
    ds_read_b64_tr_b16 a[146:147], v16 offset:2560
    ds_read_b64_tr_b16 a[148:149], v17 offset:2048
    ds_read_b64_tr_b16 a[150:151], v17 offset:2560
    ds_read_b64_tr_b16 a[152:153], v16 offset:4096
    ds_read_b64_tr_b16 a[154:155], v16 offset:4608
    ds_read_b64_tr_b16 a[156:157], v17 offset:4096
    ds_read_b64_tr_b16 a[158:159], v17 offset:4608
    ds_read_b64_tr_b16 a[160:161], v16 offset:6144
    ds_read_b64_tr_b16 a[162:163], v16 offset:6656
    ds_read_b64_tr_b16 a[164:165], v17 offset:6144
    ds_read_b64_tr_b16 a[166:167], v17 offset:6656
    s_waitcnt lgkmcnt(0)
    s_barrier
    s_add_u32 m0, s58, 98304
    s_add_u32 s47, s57, 0
    buffer_load_dwordx4 v11, s[24:27], s47 offen lds
    s_add_u32 m0, s58, 100352
    s_add_u32 s47, s57, 16384
    buffer_load_dwordx4 v11, s[24:27], s47 offen lds
    s_add_u32 m0, s58, 102400
    s_add_u32 s47, s57, 32768
    buffer_load_dwordx4 v11, s[24:27], s47 offen lds
    s_add_u32 m0, s58, 104448
    s_add_u32 s47, s57, 49152
    buffer_load_dwordx4 v11, s[24:27], s47 offen lds
    s_add_u32 m0, s58, 114688
    s_add_u32 s47, s57, 65536
    buffer_load_dwordx4 v11, s[24:27], s47 offen lds
    s_add_u32 m0, s58, 116736
    s_add_u32 s47, s57, 81920
    buffer_load_dwordx4 v11, s[24:27], s47 offen lds
    s_add_u32 m0, s58, 118784
    s_add_u32 s47, s57, 98304
    buffer_load_dwordx4 v11, s[24:27], s47 offen lds
    s_add_u32 m0, s58, 120832
    s_add_u32 s47, s57, 114688
    buffer_load_dwordx4 v11, s[24:27], s47 offen lds
    s_add_u32 m0, s58, 131072
    s_add_u32 s47, s57, 131072
    buffer_load_dwordx4 v11, s[24:27], s47 offen lds
    s_add_u32 m0, s58, 133120
    s_add_u32 s47, s57, 147456
    buffer_load_dwordx4 v11, s[24:27], s47 offen lds
    s_add_u32 m0, s58, 135168
    s_add_u32 s47, s57, 163840
    buffer_load_dwordx4 v11, s[24:27], s47 offen lds
    s_add_u32 m0, s58, 137216
    s_add_u32 s47, s57, 180224
    buffer_load_dwordx4 v11, s[24:27], s47 offen lds
    s_add_u32 m0, s58, 0
    s_add_u32 s47, s57, 196608
    buffer_load_dwordx4 v11, s[24:27], s47 offen lds
    s_add_u32 m0, s58, 2048
    s_add_u32 s47, s57, 212992
    buffer_load_dwordx4 v11, s[24:27], s47 offen lds
    s_add_u32 m0, s58, 4096
    s_add_u32 s47, s57, 229376
    buffer_load_dwordx4 v11, s[24:27], s47 offen lds
    s_add_u32 m0, s58, 6144
    s_add_u32 s47, s57, 245760
    buffer_load_dwordx4 v11, s[24:27], s47 offen lds
    s_add_u32 m0, s58, 16384
    s_add_u32 s47, s57, 262144
    buffer_load_dwordx4 v11, s[24:27], s47 offen lds
    s_add_u32 m0, s58, 18432
    s_add_u32 s47, s57, 278528
    buffer_load_dwordx4 v11, s[24:27], s47 offen lds
    s_add_u32 m0, s58, 20480
    s_add_u32 s47, s57, 294912
    buffer_load_dwordx4 v11, s[24:27], s47 offen lds
    s_add_u32 m0, s58, 22528
    s_add_u32 s47, s57, 311296
    buffer_load_dwordx4 v11, s[24:27], s47 offen lds
    s_add_u32 m0, s58, 32768
    s_add_u32 s47, s57, 327680
    buffer_load_dwordx4 v11, s[24:27], s47 offen lds
    s_add_u32 m0, s58, 34816
    s_add_u32 s47, s57, 344064
    buffer_load_dwordx4 v11, s[24:27], s47 offen lds
    s_add_u32 m0, s58, 36864
    s_add_u32 s47, s57, 360448
    buffer_load_dwordx4 v11, s[24:27], s47 offen lds
    s_add_u32 m0, s58, 38912
    s_add_u32 s47, s57, 376832
    buffer_load_dwordx4 v11, s[24:27], s47 offen lds
    s_add_u32 m0, s58, 49152
    s_add_u32 s47, s57, 393216
    buffer_load_dwordx4 v11, s[24:27], s47 offen lds
    s_add_u32 m0, s58, 51200
    s_add_u32 s47, s57, 409600
    buffer_load_dwordx4 v11, s[24:27], s47 offen lds
    s_add_u32 m0, s58, 53248
    s_add_u32 s47, s57, 425984
    buffer_load_dwordx4 v11, s[24:27], s47 offen lds
    s_add_u32 m0, s58, 55296
    s_add_u32 s47, s57, 442368
    buffer_load_dwordx4 v11, s[24:27], s47 offen lds
    s_add_u32 m0, s58, 65536
    s_add_u32 s47, s57, 458752
    buffer_load_dwordx4 v11, s[24:27], s47 offen lds
    s_add_u32 m0, s58, 67584
    s_add_u32 s47, s57, 475136
    buffer_load_dwordx4 v11, s[24:27], s47 offen lds
    s_add_u32 m0, s58, 69632
    s_add_u32 s47, s57, 491520
    buffer_load_dwordx4 v11, s[24:27], s47 offen lds
    s_add_u32 m0, s58, 71680
    s_add_u32 s47, s57, 507904
    buffer_load_dwordx4 v11, s[24:27], s47 offen lds
    s_add_u32 m0, s58, 81920
    s_add_u32 s47, s57, 524288
    buffer_load_dwordx4 v11, s[24:27], s47 offen lds
    s_add_u32 m0, s58, 83968
    s_add_u32 s47, s57, 540672
    buffer_load_dwordx4 v11, s[24:27], s47 offen lds
    s_add_u32 m0, s58, 86016
    s_add_u32 s47, s57, 557056
    buffer_load_dwordx4 v11, s[24:27], s47 offen lds
    s_add_u32 m0, s58, 88064
    s_add_u32 s47, s57, 573440
    buffer_load_dwordx4 v11, s[24:27], s47 offen lds
    v_bfe_u32 v114, v1, 2, 1
    v_lshlrev_b32 v114, 4, v114
    v_bfe_u32 v115, v1, 3, 2
    v_lshl_add_u32 v114, v115, 2, v114
    v_and_b32 v115, 3, v1
    v_add_u32 v114, v114, v115
    s_lshl_b32 s49, s55, 1
    s_add_u32 s49, s49, s52
    s_lshl_b32 s49, s49, 5
    v_add_u32 v114, s49, v114
    v_cvt_f32_u32 v114, v114
    v_mul_f32 v118, 0x3b000000, v114
    v_lshrrev_b32 v115, 5, v1
    v_lshl_add_u32 v115, v115, 2, 1
    v_cvt_f32_u32 v115, v115
    v_mul_f32 v119, v115, v118
    v_mul_f32 v120, 4.0, v118
    v_and_b32 v114, 1, v1
    v_lshlrev_b32 v121, 4, v114
    v_bfe_u32 v115, v1, 1, 1
    v_xor_b32 v114, v114, v115
    v_lshlrev_b32 v114, 15, v114
    v_lshl_or_b32 v114, v115, 31, v114
    v_cos_f32 v116, v119
    v_sin_f32 v117, v119
    v_add_f32 v119, v119, v118
    v_cvt_pk_bf16_f32 v176, v116, v117
    v_alignbit_b32 v115, v176, v176, v121
    v_xor_b32 v24, v115, v114
    v_cos_f32 v116, v119
    v_sin_f32 v117, v119
    v_add_f32 v119, v119, v118
    v_cvt_pk_bf16_f32 v177, v116, v117
    v_alignbit_b32 v115, v177, v177, v121
    v_xor_b32 v25, v115, v114
    v_cos_f32 v116, v119
    v_sin_f32 v117, v119
    v_add_f32 v119, v119, v118
    v_cvt_pk_bf16_f32 v178, v116, v117
    v_alignbit_b32 v115, v178, v178, v121
    v_xor_b32 v26, v115, v114
    v_cos_f32 v116, v119
    v_sin_f32 v117, v119
    v_add_f32 v119, v119, v118
    v_cvt_pk_bf16_f32 v179, v116, v117
    v_alignbit_b32 v115, v179, v179, v121
    v_xor_b32 v27, v115, v114
    v_add_f32 v119, v119, v120
    v_cos_f32 v116, v119
    v_sin_f32 v117, v119
    v_add_f32 v119, v119, v118
    v_cvt_pk_bf16_f32 v180, v116, v117
    v_alignbit_b32 v115, v180, v180, v121
    v_xor_b32 v28, v115, v114
    v_cos_f32 v116, v119
    v_sin_f32 v117, v119
    v_add_f32 v119, v119, v118
    v_cvt_pk_bf16_f32 v181, v116, v117
    v_alignbit_b32 v115, v181, v181, v121
    v_xor_b32 v29, v115, v114
    v_cos_f32 v116, v119
    v_sin_f32 v117, v119
    v_add_f32 v119, v119, v118
    v_cvt_pk_bf16_f32 v182, v116, v117
    v_alignbit_b32 v115, v182, v182, v121
    v_xor_b32 v30, v115, v114
    v_cos_f32 v116, v119
    v_sin_f32 v117, v119
    v_add_f32 v119, v119, v118
    v_cvt_pk_bf16_f32 v183, v116, v117
    v_alignbit_b32 v115, v183, v183, v121
    v_xor_b32 v31, v115, v114
    v_add_f32 v119, v119, v120
    v_cos_f32 v116, v119
    v_sin_f32 v117, v119
    v_add_f32 v119, v119, v118
    v_cvt_pk_bf16_f32 v184, v116, v117
    v_alignbit_b32 v115, v184, v184, v121
    v_xor_b32 v32, v115, v114
    v_cos_f32 v116, v119
    v_sin_f32 v117, v119
    v_add_f32 v119, v119, v118
    v_cvt_pk_bf16_f32 v185, v116, v117
    v_alignbit_b32 v115, v185, v185, v121
    v_xor_b32 v33, v115, v114
    v_cos_f32 v116, v119
    v_sin_f32 v117, v119
    v_add_f32 v119, v119, v118
    v_cvt_pk_bf16_f32 v186, v116, v117
    v_alignbit_b32 v115, v186, v186, v121
    v_xor_b32 v34, v115, v114
    v_cos_f32 v116, v119
    v_sin_f32 v117, v119
    v_add_f32 v119, v119, v118
    v_cvt_pk_bf16_f32 v187, v116, v117
    v_alignbit_b32 v115, v187, v187, v121
    v_xor_b32 v35, v115, v114
    v_add_f32 v119, v119, v120
    v_cos_f32 v116, v119
    v_sin_f32 v117, v119
    v_add_f32 v119, v119, v118
    v_cvt_pk_bf16_f32 v188, v116, v117
    v_alignbit_b32 v115, v188, v188, v121
    v_xor_b32 v36, v115, v114
    v_cos_f32 v116, v119
    v_sin_f32 v117, v119
    v_add_f32 v119, v119, v118
    v_cvt_pk_bf16_f32 v189, v116, v117
    v_alignbit_b32 v115, v189, v189, v121
    v_xor_b32 v37, v115, v114
    v_cos_f32 v116, v119
    v_sin_f32 v117, v119
    v_add_f32 v119, v119, v118
    v_cvt_pk_bf16_f32 v190, v116, v117
    v_alignbit_b32 v115, v190, v190, v121
    v_xor_b32 v38, v115, v114
    v_cos_f32 v116, v119
    v_sin_f32 v117, v119
    v_add_f32 v119, v119, v118
    v_cvt_pk_bf16_f32 v191, v116, v117
    v_alignbit_b32 v115, v191, v191, v121
    v_xor_b32 v39, v115, v114
    v_add_f32 v119, v119, v120
    v_cos_f32 v116, v119
    v_sin_f32 v117, v119
    v_add_f32 v119, v119, v118
    v_cvt_pk_bf16_f32 v192, v116, v117
    v_alignbit_b32 v115, v192, v192, v121
    v_xor_b32 v40, v115, v114
    v_cos_f32 v116, v119
    v_sin_f32 v117, v119
    v_add_f32 v119, v119, v118
    v_cvt_pk_bf16_f32 v193, v116, v117
    v_alignbit_b32 v115, v193, v193, v121
    v_xor_b32 v41, v115, v114
    v_cos_f32 v116, v119
    v_sin_f32 v117, v119
    v_add_f32 v119, v119, v118
    v_cvt_pk_bf16_f32 v194, v116, v117
    v_alignbit_b32 v115, v194, v194, v121
    v_and_b32 v15, 15, v1
    v_min_u32 v15, 13, v15
    v_lshlrev_b32 v15, 4, v15
    s_lshr_b32 s51, s54, 2
    s_lshl_b32 s51, s51, 8
    s_add_u32 s51, s51, 0x1111000
    buffer_load_dword v126, v15, s[32:35], s51 offen sc1
    s_waitcnt vmcnt(0)
L_C:
    s_waitcnt vmcnt(4)
    v_cmp_ne_u32 vcc, s37, v126
    s_nop 1
    s_cbranch_vccnz L_s3_spin
L_s3_ok:
    s_add_u32 s46, s56, 0
    buffer_load_dwordx4 a[0:3], v10, s[32:35], s46 offen offset:0 sc1
    buffer_load_dwordx4 a[4:7], v10, s[32:35], s46 offen offset:1024 sc1
    buffer_load_dwordx4 a[8:11], v10, s[32:35], s46 offen offset:2048 sc1
    buffer_load_dwordx4 a[12:15], v10, s[32:35], s46 offen offset:3072 sc1
    s_waitcnt lgkmcnt(0)
    s_barrier
    ds_read_b64_tr_b16 v[96:97], v18 offset:32768
    ds_read_b64_tr_b16 v[98:99], v18 offset:33280
    ds_read_b64_tr_b16 v[100:101], v19 offset:32768
    ds_read_b64_tr_b16 v[102:103], v19 offset:33280
    s_add_u32 s46, s56, 4096
    buffer_load_dwordx4 a[16:19], v10, s[32:35], s46 offen offset:0 sc1
    buffer_load_dwordx4 a[20:23], v10, s[32:35], s46 offen offset:1024 sc1
    buffer_load_dwordx4 a[24:27], v10, s[32:35], s46 offen offset:2048 sc1
    buffer_load_dwordx4 a[28:31], v10, s[32:35], s46 offen offset:3072 sc1
    s_add_u32 s46, s56, 8192
    buffer_load_dwordx4 a[32:35], v10, s[32:35], s46 offen offset:0 sc1
    buffer_load_dwordx4 a[36:39], v10, s[32:35], s46 offen offset:1024 sc1
    s_lshl_b32 s44, s2, 3
    s_add_u32 s44, s44, 0x1119000
    s_cmp_lg_u32 s36, 0
    s_cbranch_scc1 L_f4
    v_mov_b32 v124, s37
    v_mov_b32 v125, 0
    s_mov_b64 exec, 1
    buffer_store_dword v124, v125, s[32:35], s44 offen sc1
    s_mov_b64 exec, -1
L_f4:
    v_xor_b32 v42, v115, v114
    v_cos_f32 v116, v119
    v_sin_f32 v117, v119
    v_add_f32 v119, v119, v118
    v_cvt_pk_bf16_f32 v195, v116, v117
    v_alignbit_b32 v115, v195, v195, v121
    v_xor_b32 v43, v115, v114
    v_add_f32 v119, v119, v120
    v_cos_f32 v116, v119
    v_sin_f32 v117, v119
    v_add_f32 v119, v119, v118
    v_cvt_pk_bf16_f32 v196, v116, v117
    v_alignbit_b32 v115, v196, v196, v121
    v_xor_b32 v44, v115, v114
    v_cos_f32 v116, v119
    v_sin_f32 v117, v119
    v_add_f32 v119, v119, v118
    v_cvt_pk_bf16_f32 v197, v116, v117
    v_alignbit_b32 v115, v197, v197, v121
    v_xor_b32 v45, v115, v114
    v_cos_f32 v116, v119
    v_sin_f32 v117, v119
    v_add_f32 v119, v119, v118
    v_cvt_pk_bf16_f32 v198, v116, v117
    v_alignbit_b32 v115, v198, v198, v121
    v_xor_b32 v46, v115, v114
    v_cos_f32 v116, v119
    v_sin_f32 v117, v119
    v_add_f32 v119, v119, v118
    v_cvt_pk_bf16_f32 v199, v116, v117
    s_waitcnt vmcnt(9) lgkmcnt(0)
    v_mfma_f32_32x32x16_bf16 v[128:143], v[96:99], a[0:3], 0
    ds_read_b64_tr_b16 v[104:105], v18 offset:34816
    ds_read_b64_tr_b16 v[106:107], v18 offset:35328
    ds_read_b64_tr_b16 v[108:109], v19 offset:34816
    ds_read_b64_tr_b16 v[110:111], v19 offset:35328
    v_mfma_f32_32x32x16_bf16 v[144:159], v[100:103], a[0:3], 0
    buffer_load_dwordx4 a[40:43], v10, s[32:35], s46 offen offset:2048 sc1
    buffer_load_dwordx4 a[44:47], v10, s[32:35], s46 offen offset:3072 sc1
    s_add_u32 m0, s58, 147456
    s_add_u32 s47, s57, 589824
    buffer_load_dwordx4 v11, s[24:27], s47 offen lds
    v_alignbit_b32 v115, v199, v199, v121
    v_xor_b32 v47, v115, v114
    v_add_f32 v119, v119, v120
    v_cos_f32 v116, v119
    v_sin_f32 v117, v119
    s_waitcnt vmcnt(11) lgkmcnt(0)
    v_mfma_f32_32x32x16_bf16 v[128:143], v[104:107], a[4:7], v[128:143]
    ds_read_b64_tr_b16 v[96:97], v18 offset:36864
    ds_read_b64_tr_b16 v[98:99], v18 offset:37376
    ds_read_b64_tr_b16 v[100:101], v19 offset:36864
    ds_read_b64_tr_b16 v[102:103], v19 offset:37376
    v_mfma_f32_32x32x16_bf16 v[144:159], v[108:111], a[4:7], v[144:159]
    s_add_u32 s46, s56, 12288
    buffer_load_dwordx4 a[48:51], v10, s[32:35], s46 offen offset:0 sc1
    buffer_load_dwordx4 a[52:55], v10, s[32:35], s46 offen offset:1024 sc1
    s_add_u32 m0, s58, 149504
    s_add_u32 s47, s57, 606208
    buffer_load_dwordx4 v11, s[24:27], s47 offen lds
    v_add_f32 v119, v119, v118
    v_cvt_pk_bf16_f32 v200, v116, v117
    v_alignbit_b32 v115, v200, v200, v121
    v_xor_b32 v48, v115, v114
    v_cos_f32 v116, v119
    s_waitcnt vmcnt(13) lgkmcnt(0)
    v_mfma_f32_32x32x16_bf16 v[128:143], v[96:99], a[8:11], v[128:143]
    ds_read_b64_tr_b16 v[104:105], v18 offset:38912
    ds_read_b64_tr_b16 v[106:107], v18 offset:39424
    ds_read_b64_tr_b16 v[108:109], v19 offset:38912
    ds_read_b64_tr_b16 v[110:111], v19 offset:39424
    v_mfma_f32_32x32x16_bf16 v[144:159], v[100:103], a[8:11], v[144:159]
    buffer_load_dwordx4 a[56:59], v10, s[32:35], s46 offen offset:2048 sc1
    s_add_u32 m0, s58, 151552
    s_add_u32 s47, s57, 622592
    buffer_load_dwordx4 v11, s[24:27], s47 offen lds
    v_sin_f32 v117, v119
    v_add_f32 v119, v119, v118
    v_cvt_pk_bf16_f32 v201, v116, v117
    v_alignbit_b32 v115, v201, v201, v121
    v_xor_b32 v49, v115, v114
    s_waitcnt vmcnt(14) lgkmcnt(0)
    v_mfma_f32_32x32x16_bf16 v[128:143], v[104:107], a[12:15], v[128:143]
    s_barrier
    ds_read_b64_tr_b16 v[96:97], v18 offset:49152
    ds_read_b64_tr_b16 v[98:99], v18 offset:49664
    ds_read_b64_tr_b16 v[100:101], v19 offset:49152
    ds_read_b64_tr_b16 v[102:103], v19 offset:49664
    v_mfma_f32_32x32x16_bf16 v[144:159], v[108:111], a[12:15], v[144:159]
    buffer_load_dwordx4 a[60:63], v10, s[32:35], s46 offen offset:3072 sc1
    s_add_u32 m0, s58, 153600
    s_add_u32 s47, s57, 638976
    buffer_load_dwordx4 v11, s[24:27], s47 offen lds
    v_cos_f32 v116, v119
    v_sin_f32 v117, v119
    v_add_f32 v119, v119, v118
    v_cvt_pk_bf16_f32 v202, v116, v117
    v_alignbit_b32 v115, v202, v202, v121
    s_waitcnt vmcnt(15) lgkmcnt(0)
    v_mfma_f32_32x32x16_bf16 v[128:143], v[96:99], a[16:19], v[128:143]
    ds_read_b64_tr_b16 v[104:105], v18 offset:51200
    ds_read_b64_tr_b16 v[106:107], v18 offset:51712
    ds_read_b64_tr_b16 v[108:109], v19 offset:51200
    ds_read_b64_tr_b16 v[110:111], v19 offset:51712
    v_mfma_f32_32x32x16_bf16 v[144:159], v[100:103], a[16:19], v[144:159]
    s_add_u32 s46, s56, 16384
    buffer_load_dwordx4 a[0:3], v10, s[32:35], s46 offen offset:0 sc1
    s_add_u32 m0, s58, 98304
    s_add_u32 s47, s57, 655360
    buffer_load_dwordx4 v11, s[24:27], s47 offen lds
    v_xor_b32 v50, v115, v114
    v_cos_f32 v116, v119
    v_sin_f32 v117, v119
    v_add_f32 v119, v119, v118
    v_cvt_pk_bf16_f32 v203, v116, v117
    s_waitcnt vmcnt(16) lgkmcnt(0)
    v_mfma_f32_32x32x16_bf16 v[128:143], v[104:107], a[20:23], v[128:143]
    ds_read_b64_tr_b16 v[96:97], v18 offset:53248
    ds_read_b64_tr_b16 v[98:99], v18 offset:53760
    ds_read_b64_tr_b16 v[100:101], v19 offset:53248
    ds_read_b64_tr_b16 v[102:103], v19 offset:53760
    v_mfma_f32_32x32x16_bf16 v[144:159], v[108:111], a[20:23], v[144:159]
    buffer_load_dwordx4 a[4:7], v10, s[32:35], s46 offen offset:1024 sc1
    s_add_u32 m0, s58, 100352
    s_add_u32 s47, s57, 671744
    buffer_load_dwordx4 v11, s[24:27], s47 offen lds
    v_alignbit_b32 v115, v203, v203, v121
    v_xor_b32 v51, v115, v114
    v_add_f32 v119, v119, v120
    v_cos_f32 v116, v119
    v_sin_f32 v117, v119
    s_waitcnt vmcnt(17) lgkmcnt(0)
    v_mfma_f32_32x32x16_bf16 v[128:143], v[96:99], a[24:27], v[128:143]
    ds_read_b64_tr_b16 v[104:105], v18 offset:55296
    ds_read_b64_tr_b16 v[106:107], v18 offset:55808
    ds_read_b64_tr_b16 v[108:109], v19 offset:55296
    ds_read_b64_tr_b16 v[110:111], v19 offset:55808
    v_mfma_f32_32x32x16_bf16 v[144:159], v[100:103], a[24:27], v[144:159]
    buffer_load_dwordx4 a[8:11], v10, s[32:35], s46 offen offset:2048 sc1
    s_add_u32 m0, s58, 102400
    s_add_u32 s47, s57, 688128
    buffer_load_dwordx4 v11, s[24:27], s47 offen lds
    v_add_f32 v119, v119, v118
    v_cvt_pk_bf16_f32 v204, v116, v117
    v_alignbit_b32 v115, v204, v204, v121
    v_xor_b32 v52, v115, v114
    v_cos_f32 v116, v119
    s_waitcnt vmcnt(18) lgkmcnt(0)
    v_mfma_f32_32x32x16_bf16 v[128:143], v[104:107], a[28:31], v[128:143]
    s_barrier
    ds_read_b64_tr_b16 v[96:97], v20 offset:0
    ds_read_b64_tr_b16 v[98:99], v20 offset:512
    ds_read_b64_tr_b16 v[100:101], v21 offset:0
    ds_read_b64_tr_b16 v[102:103], v21 offset:512
    v_mfma_f32_32x32x16_bf16 v[144:159], v[108:111], a[28:31], v[144:159]
    buffer_load_dwordx4 a[12:15], v10, s[32:35], s46 offen offset:3072 sc1
    s_add_u32 m0, s58, 104448
    s_add_u32 s47, s57, 704512
    buffer_load_dwordx4 v11, s[24:27], s47 offen lds
    v_sin_f32 v117, v119
    v_add_f32 v119, v119, v118
    v_cvt_pk_bf16_f32 v205, v116, v117
    v_alignbit_b32 v115, v205, v205, v121
    v_xor_b32 v53, v115, v114
    s_waitcnt vmcnt(19) lgkmcnt(0)
    v_mfma_f32_32x32x16_bf16 v[128:143], v[96:99], a[32:35], v[128:143]
    ds_read_b64_tr_b16 v[104:105], v20 offset:2048
    ds_read_b64_tr_b16 v[106:107], v20 offset:2560
    ds_read_b64_tr_b16 v[108:109], v21 offset:2048
    ds_read_b64_tr_b16 v[110:111], v21 offset:2560
    v_mfma_f32_32x32x16_bf16 v[144:159], v[100:103], a[32:35], v[144:159]
    s_add_u32 s46, s56, 20480
    buffer_load_dwordx4 a[16:19], v10, s[32:35], s46 offen offset:0 sc1
    s_add_u32 m0, s58, 114688
    s_add_u32 s47, s57, 720896
    buffer_load_dwordx4 v11, s[24:27], s47 offen lds
    v_cos_f32 v116, v119
    v_sin_f32 v117, v119
    v_add_f32 v119, v119, v118
    v_cvt_pk_bf16_f32 v206, v116, v117
    v_alignbit_b32 v115, v206, v206, v121
    s_waitcnt vmcnt(20) lgkmcnt(0)
    v_mfma_f32_32x32x16_bf16 v[128:143], v[104:107], a[36:39], v[128:143]
    ds_read_b64_tr_b16 v[96:97], v20 offset:4096
    ds_read_b64_tr_b16 v[98:99], v20 offset:4608
    ds_read_b64_tr_b16 v[100:101], v21 offset:4096
    ds_read_b64_tr_b16 v[102:103], v21 offset:4608
    v_mfma_f32_32x32x16_bf16 v[144:159], v[108:111], a[36:39], v[144:159]
    buffer_load_dwordx4 a[20:23], v10, s[32:35], s46 offen offset:1024 sc1
    s_add_u32 m0, s58, 116736
    s_add_u32 s47, s57, 737280
    buffer_load_dwordx4 v11, s[24:27], s47 offen lds
    v_xor_b32 v54, v115, v114
    v_cos_f32 v116, v119
    v_sin_f32 v117, v119
    v_add_f32 v119, v119, v118
    v_cvt_pk_bf16_f32 v207, v116, v117
    s_waitcnt vmcnt(21) lgkmcnt(0)
    v_mfma_f32_32x32x16_bf16 v[128:143], v[96:99], a[40:43], v[128:143]
    ds_read_b64_tr_b16 v[104:105], v20 offset:6144
    ds_read_b64_tr_b16 v[106:107], v20 offset:6656
    ds_read_b64_tr_b16 v[108:109], v21 offset:6144
    ds_read_b64_tr_b16 v[110:111], v21 offset:6656
    v_mfma_f32_32x32x16_bf16 v[144:159], v[100:103], a[40:43], v[144:159]
    buffer_load_dwordx4 a[24:27], v10, s[32:35], s46 offen offset:2048 sc1
    s_add_u32 m0, s58, 118784
    s_add_u32 s47, s57, 753664
    buffer_load_dwordx4 v11, s[24:27], s47 offen lds
    v_alignbit_b32 v115, v207, v207, v121
    v_xor_b32 v55, v115, v114
    v_add_f32 v119, v119, v120
    v_cos_f32 v116, v119
    v_sin_f32 v117, v119
    s_waitcnt vmcnt(22) lgkmcnt(0)
    v_mfma_f32_32x32x16_bf16 v[128:143], v[104:107], a[44:47], v[128:143]
    s_barrier
    ds_read_b64_tr_b16 v[96:97], v16 offset:0
    ds_read_b64_tr_b16 v[98:99], v16 offset:512
    ds_read_b64_tr_b16 v[100:101], v17 offset:0
    ds_read_b64_tr_b16 v[102:103], v17 offset:512
    v_mfma_f32_32x32x16_bf16 v[144:159], v[108:111], a[44:47], v[144:159]
    buffer_load_dwordx4 a[28:31], v10, s[32:35], s46 offen offset:3072 sc1
    s_add_u32 m0, s58, 120832
    s_add_u32 s47, s57, 770048
    buffer_load_dwordx4 v11, s[24:27], s47 offen lds
    v_add_f32 v119, v119, v118
    v_cvt_pk_bf16_f32 v208, v116, v117
    v_alignbit_b32 v115, v208, v208, v121
    v_xor_b32 v56, v115, v114
    v_cos_f32 v116, v119
    s_waitcnt vmcnt(22) lgkmcnt(0)
    v_mfma_f32_32x32x16_bf16 v[128:143], v[96:99], a[48:51], v[128:143]
    ds_read_b64_tr_b16 v[104:105], v16 offset:2048
    ds_read_b64_tr_b16 v[106:107], v16 offset:2560
    ds_read_b64_tr_b16 v[108:109], v17 offset:2048
    ds_read_b64_tr_b16 v[110:111], v17 offset:2560
    v_mfma_f32_32x32x16_bf16 v[144:159], v[100:103], a[48:51], v[144:159]
    s_add_u32 s46, s56, 24576
    buffer_load_dwordx4 a[32:35], v10, s[32:35], s46 offen offset:0 sc1
    s_add_u32 m0, s58, 131072
    s_add_u32 s47, s57, 786432
    buffer_load_dwordx4 v11, s[24:27], s47 offen lds
    v_sin_f32 v117, v119
    v_add_f32 v119, v119, v118
    v_cvt_pk_bf16_f32 v209, v116, v117
    v_alignbit_b32 v115, v209, v209, v121
    v_xor_b32 v57, v115, v114
    s_waitcnt vmcnt(23) lgkmcnt(0)
    v_mfma_f32_32x32x16_bf16 v[128:143], v[104:107], a[52:55], v[128:143]
    ds_read_b64_tr_b16 v[96:97], v16 offset:4096
    ds_read_b64_tr_b16 v[98:99], v16 offset:4608
    ds_read_b64_tr_b16 v[100:101], v17 offset:4096
    ds_read_b64_tr_b16 v[102:103], v17 offset:4608
    v_mfma_f32_32x32x16_bf16 v[144:159], v[108:111], a[52:55], v[144:159]
    buffer_load_dwordx4 a[36:39], v10, s[32:35], s46 offen offset:1024 sc1
    s_add_u32 m0, s58, 133120
    s_add_u32 s47, s57, 802816
    buffer_load_dwordx4 v11, s[24:27], s47 offen lds
    v_cos_f32 v116, v119
    v_sin_f32 v117, v119
    v_add_f32 v119, v119, v118
    v_cvt_pk_bf16_f32 v210, v116, v117
    v_alignbit_b32 v115, v210, v210, v121
    s_waitcnt vmcnt(23) lgkmcnt(0)
    v_mfma_f32_32x32x16_bf16 v[128:143], v[96:99], a[56:59], v[128:143]
    ds_read_b64_tr_b16 v[104:105], v16 offset:6144
    ds_read_b64_tr_b16 v[106:107], v16 offset:6656
    ds_read_b64_tr_b16 v[108:109], v17 offset:6144
    ds_read_b64_tr_b16 v[110:111], v17 offset:6656
    v_mfma_f32_32x32x16_bf16 v[144:159], v[100:103], a[56:59], v[144:159]
    buffer_load_dwordx4 a[40:43], v10, s[32:35], s46 offen offset:2048 sc1
    s_add_u32 m0, s58, 135168
    s_add_u32 s47, s57, 819200
    buffer_load_dwordx4 v11, s[24:27], s47 offen lds
    v_xor_b32 v58, v115, v114
    v_cos_f32 v116, v119
    v_sin_f32 v117, v119
    v_add_f32 v119, v119, v118
    v_cvt_pk_bf16_f32 v211, v116, v117
    s_waitcnt vmcnt(23) lgkmcnt(0)
    v_mfma_f32_32x32x16_bf16 v[128:143], v[104:107], a[60:63], v[128:143]
    s_barrier
    ds_read_b64_tr_b16 v[96:97], v16 offset:16384
    ds_read_b64_tr_b16 v[98:99], v16 offset:16896
    ds_read_b64_tr_b16 v[100:101], v17 offset:16384
    ds_read_b64_tr_b16 v[102:103], v17 offset:16896
    v_mfma_f32_32x32x16_bf16 v[144:159], v[108:111], a[60:63], v[144:159]
    buffer_load_dwordx4 a[44:47], v10, s[32:35], s46 offen offset:3072 sc1
    s_add_u32 m0, s58, 137216
    s_add_u32 s47, s57, 835584
    buffer_load_dwordx4 v11, s[24:27], s47 offen lds
    v_alignbit_b32 v115, v211, v211, v121
    v_xor_b32 v59, v115, v114
    v_add_f32 v119, v119, v120
    v_cos_f32 v116, v119
    v_sin_f32 v117, v119
    s_waitcnt vmcnt(23) lgkmcnt(0)
    v_mfma_f32_32x32x16_bf16 v[128:143], v[96:99], a[0:3], v[128:143]
    ds_read_b64_tr_b16 v[104:105], v16 offset:18432
    ds_read_b64_tr_b16 v[106:107], v16 offset:18944
    ds_read_b64_tr_b16 v[108:109], v17 offset:18432
    ds_read_b64_tr_b16 v[110:111], v17 offset:18944
    v_mfma_f32_32x32x16_bf16 v[144:159], v[100:103], a[0:3], v[144:159]
    s_add_u32 s46, s56, 28672
    buffer_load_dwordx4 a[48:51], v10, s[32:35], s46 offen offset:0 sc1
    v_add_f32 v119, v119, v118
    v_cvt_pk_bf16_f32 v212, v116, v117
    v_alignbit_b32 v115, v212, v212, v121
    v_xor_b32 v60, v115, v114
    v_cos_f32 v116, v119
    s_waitcnt vmcnt(22) lgkmcnt(0)
    v_mfma_f32_32x32x16_bf16 v[128:143], v[104:107], a[4:7], v[128:143]
    ds_read_b64_tr_b16 v[96:97], v16 offset:20480
    ds_read_b64_tr_b16 v[98:99], v16 offset:20992
    ds_read_b64_tr_b16 v[100:101], v17 offset:20480
    ds_read_b64_tr_b16 v[102:103], v17 offset:20992
    v_mfma_f32_32x32x16_bf16 v[144:159], v[108:111], a[4:7], v[144:159]
    buffer_load_dwordx4 a[52:55], v10, s[32:35], s46 offen offset:1024 sc1
    v_sin_f32 v117, v119
    v_add_f32 v119, v119, v118
    v_cvt_pk_bf16_f32 v213, v116, v117
    v_alignbit_b32 v115, v213, v213, v121
    v_xor_b32 v61, v115, v114
    s_waitcnt vmcnt(21) lgkmcnt(0)
    v_mfma_f32_32x32x16_bf16 v[128:143], v[96:99], a[8:11], v[128:143]
    ds_read_b64_tr_b16 v[104:105], v16 offset:22528
    ds_read_b64_tr_b16 v[106:107], v16 offset:23040
    ds_read_b64_tr_b16 v[108:109], v17 offset:22528
    ds_read_b64_tr_b16 v[110:111], v17 offset:23040
    v_mfma_f32_32x32x16_bf16 v[144:159], v[100:103], a[8:11], v[144:159]
    buffer_load_dwordx4 a[56:59], v10, s[32:35], s46 offen offset:2048 sc1
    v_cos_f32 v116, v119
    v_sin_f32 v117, v119
    v_add_f32 v119, v119, v118
    v_cvt_pk_bf16_f32 v214, v116, v117
    v_alignbit_b32 v115, v214, v214, v121
    s_waitcnt vmcnt(20) lgkmcnt(0)
    v_mfma_f32_32x32x16_bf16 v[128:143], v[104:107], a[12:15], v[128:143]
    ds_read_b64_tr_b16 v[96:97], v16 offset:32768
    ds_read_b64_tr_b16 v[98:99], v16 offset:33280
    ds_read_b64_tr_b16 v[100:101], v17 offset:32768
    ds_read_b64_tr_b16 v[102:103], v17 offset:33280
    v_mfma_f32_32x32x16_bf16 v[144:159], v[108:111], a[12:15], v[144:159]
    buffer_load_dwordx4 a[60:63], v10, s[32:35], s46 offen offset:3072 sc1
    v_xor_b32 v62, v115, v114
    v_cos_f32 v116, v119
    v_sin_f32 v117, v119
    v_add_f32 v119, v119, v118
    v_cvt_pk_bf16_f32 v215, v116, v117
    s_waitcnt vmcnt(19) lgkmcnt(0)
    v_mfma_f32_32x32x16_bf16 v[128:143], v[96:99], a[16:19], v[128:143]
    ds_read_b64_tr_b16 v[104:105], v16 offset:34816
    ds_read_b64_tr_b16 v[106:107], v16 offset:35328
    ds_read_b64_tr_b16 v[108:109], v17 offset:34816
    ds_read_b64_tr_b16 v[110:111], v17 offset:35328
    v_mfma_f32_32x32x16_bf16 v[144:159], v[100:103], a[16:19], v[144:159]
    s_lshl_b32 s51, s36, 9
    s_add_u32 s51, s51, 0x1119000
    v_lshlrev_b32 v15, 3, v1
    buffer_load_dword v126, v15, s[32:35], s51 offen sc1
    s_add_u32 s46, s56, 32768
    buffer_load_dwordx4 a[0:3], v10, s[32:35], s46 offen offset:0 sc1
    v_alignbit_b32 v115, v215, v215, v121
    v_xor_b32 v63, v115, v114
    v_add_f32 v119, v119, v120
    v_cos_f32 v116, v119
    v_sin_f32 v117, v119
    s_waitcnt vmcnt(19) lgkmcnt(0)
    v_mfma_f32_32x32x16_bf16 v[128:143], v[104:107], a[20:23], v[128:143]
    ds_read_b64_tr_b16 v[96:97], v16 offset:36864
    ds_read_b64_tr_b16 v[98:99], v16 offset:37376
    ds_read_b64_tr_b16 v[100:101], v17 offset:36864
    ds_read_b64_tr_b16 v[102:103], v17 offset:37376
    v_mfma_f32_32x32x16_bf16 v[144:159], v[108:111], a[20:23], v[144:159]
    buffer_load_dwordx4 a[4:7], v10, s[32:35], s46 offen offset:1024 sc1
    v_add_f32 v119, v119, v118
    v_cvt_pk_bf16_f32 v216, v116, v117
    v_alignbit_b32 v115, v216, v216, v121
    v_xor_b32 v64, v115, v114
    v_cos_f32 v116, v119
    s_waitcnt vmcnt(18) lgkmcnt(0)
    v_mfma_f32_32x32x16_bf16 v[128:143], v[96:99], a[24:27], v[128:143]
    ds_read_b64_tr_b16 v[104:105], v16 offset:38912
    ds_read_b64_tr_b16 v[106:107], v16 offset:39424
    ds_read_b64_tr_b16 v[108:109], v17 offset:38912
    ds_read_b64_tr_b16 v[110:111], v17 offset:39424
    v_mfma_f32_32x32x16_bf16 v[144:159], v[100:103], a[24:27], v[144:159]
    buffer_load_dwordx4 a[8:11], v10, s[32:35], s46 offen offset:2048 sc1
    v_sin_f32 v117, v119
    v_add_f32 v119, v119, v118
    v_cvt_pk_bf16_f32 v217, v116, v117
    v_alignbit_b32 v115, v217, v217, v121
    v_xor_b32 v65, v115, v114
    s_waitcnt vmcnt(17) lgkmcnt(0)
    v_mfma_f32_32x32x16_bf16 v[128:143], v[104:107], a[28:31], v[128:143]
    ds_read_b64_tr_b16 v[96:97], v16 offset:49152
    ds_read_b64_tr_b16 v[98:99], v16 offset:49664
    ds_read_b64_tr_b16 v[100:101], v17 offset:49152
    ds_read_b64_tr_b16 v[102:103], v17 offset:49664
    v_mfma_f32_32x32x16_bf16 v[144:159], v[108:111], a[28:31], v[144:159]
    buffer_load_dwordx4 a[12:15], v10, s[32:35], s46 offen offset:3072 sc1
    v_cos_f32 v116, v119
    v_sin_f32 v117, v119
    v_add_f32 v119, v119, v118
    v_cvt_pk_bf16_f32 v218, v116, v117
    v_alignbit_b32 v115, v218, v218, v121
    s_waitcnt vmcnt(16) lgkmcnt(0)
    v_mfma_f32_32x32x16_bf16 v[128:143], v[96:99], a[32:35], v[128:143]
    ds_read_b64_tr_b16 v[104:105], v16 offset:51200
    ds_read_b64_tr_b16 v[106:107], v16 offset:51712
    ds_read_b64_tr_b16 v[108:109], v17 offset:51200
    ds_read_b64_tr_b16 v[110:111], v17 offset:51712
    v_mfma_f32_32x32x16_bf16 v[144:159], v[100:103], a[32:35], v[144:159]
    s_add_u32 s46, s56, 36864
    buffer_load_dwordx4 a[16:19], v10, s[32:35], s46 offen offset:0 sc1
    v_xor_b32 v66, v115, v114
    v_cos_f32 v116, v119
    v_sin_f32 v117, v119
    v_add_f32 v119, v119, v118
    v_cvt_pk_bf16_f32 v219, v116, v117
    s_waitcnt vmcnt(15) lgkmcnt(0)
    v_mfma_f32_32x32x16_bf16 v[128:143], v[104:107], a[36:39], v[128:143]
    ds_read_b64_tr_b16 v[96:97], v16 offset:53248
    ds_read_b64_tr_b16 v[98:99], v16 offset:53760
    ds_read_b64_tr_b16 v[100:101], v17 offset:53248
    ds_read_b64_tr_b16 v[102:103], v17 offset:53760
    v_mfma_f32_32x32x16_bf16 v[144:159], v[108:111], a[36:39], v[144:159]
    buffer_load_dwordx4 a[20:23], v10, s[32:35], s46 offen offset:1024 sc1
    v_alignbit_b32 v115, v219, v219, v121
    v_xor_b32 v67, v115, v114
    v_add_f32 v119, v119, v120
    v_cos_f32 v116, v119
    v_sin_f32 v117, v119
    s_waitcnt vmcnt(14) lgkmcnt(0)
    v_mfma_f32_32x32x16_bf16 v[128:143], v[96:99], a[40:43], v[128:143]
    ds_read_b64_tr_b16 v[104:105], v16 offset:55296
    ds_read_b64_tr_b16 v[106:107], v16 offset:55808
    ds_read_b64_tr_b16 v[108:109], v17 offset:55296
    ds_read_b64_tr_b16 v[110:111], v17 offset:55808
    v_mfma_f32_32x32x16_bf16 v[144:159], v[100:103], a[40:43], v[144:159]
    buffer_load_dwordx4 a[24:27], v10, s[32:35], s46 offen offset:2048 sc1
    v_add_f32 v119, v119, v118
    v_cvt_pk_bf16_f32 v220, v116, v117
    v_alignbit_b32 v115, v220, v220, v121
    v_xor_b32 v68, v115, v114
    v_cos_f32 v116, v119
    s_waitcnt vmcnt(13) lgkmcnt(0)
    v_mfma_f32_32x32x16_bf16 v[128:143], v[104:107], a[44:47], v[128:143]
    ds_read_b64_tr_b16 v[96:97], v18 offset:0
    ds_read_b64_tr_b16 v[98:99], v18 offset:512
    ds_read_b64_tr_b16 v[100:101], v19 offset:0
    ds_read_b64_tr_b16 v[102:103], v19 offset:512
    v_mfma_f32_32x32x16_bf16 v[144:159], v[108:111], a[44:47], v[144:159]
    buffer_load_dwordx4 a[28:31], v10, s[32:35], s46 offen offset:3072 sc1
    v_sin_f32 v117, v119
    v_add_f32 v119, v119, v118
    v_cvt_pk_bf16_f32 v221, v116, v117
    v_alignbit_b32 v115, v221, v221, v121
    v_xor_b32 v69, v115, v114
    s_waitcnt vmcnt(12) lgkmcnt(0)
    v_mfma_f32_32x32x16_bf16 v[128:143], v[96:99], a[48:51], v[128:143]
    ds_read_b64_tr_b16 v[104:105], v18 offset:2048
    ds_read_b64_tr_b16 v[106:107], v18 offset:2560
    ds_read_b64_tr_b16 v[108:109], v19 offset:2048
    ds_read_b64_tr_b16 v[110:111], v19 offset:2560
    v_mfma_f32_32x32x16_bf16 v[144:159], v[100:103], a[48:51], v[144:159]
    s_add_u32 s46, s56, 40960
    buffer_load_dwordx4 a[32:35], v10, s[32:35], s46 offen offset:0 sc1
    v_cos_f32 v116, v119
    v_sin_f32 v117, v119
    v_add_f32 v119, v119, v118
    v_cvt_pk_bf16_f32 v222, v116, v117
    v_alignbit_b32 v115, v222, v222, v121
    s_waitcnt vmcnt(12) lgkmcnt(0)
    v_mfma_f32_32x32x16_bf16 v[128:143], v[104:107], a[52:55], v[128:143]
    ds_read_b64_tr_b16 v[96:97], v18 offset:4096
    ds_read_b64_tr_b16 v[98:99], v18 offset:4608
    ds_read_b64_tr_b16 v[100:101], v19 offset:4096
    ds_read_b64_tr_b16 v[102:103], v19 offset:4608
    v_mfma_f32_32x32x16_bf16 v[144:159], v[108:111], a[52:55], v[144:159]
    buffer_load_dwordx4 a[36:39], v10, s[32:35], s46 offen offset:1024 sc1
    v_xor_b32 v70, v115, v114
    v_cos_f32 v116, v119
    v_sin_f32 v117, v119
    v_add_f32 v119, v119, v118
    v_cvt_pk_bf16_f32 v223, v116, v117
    s_waitcnt vmcnt(12) lgkmcnt(0)
    v_mfma_f32_32x32x16_bf16 v[128:143], v[96:99], a[56:59], v[128:143]
    ds_read_b64_tr_b16 v[104:105], v18 offset:6144
    ds_read_b64_tr_b16 v[106:107], v18 offset:6656
    ds_read_b64_tr_b16 v[108:109], v19 offset:6144
    ds_read_b64_tr_b16 v[110:111], v19 offset:6656
    v_mfma_f32_32x32x16_bf16 v[144:159], v[100:103], a[56:59], v[144:159]
    buffer_load_dwordx4 a[40:43], v10, s[32:35], s46 offen offset:2048 sc1
    v_alignbit_b32 v115, v223, v223, v121
    v_xor_b32 v71, v115, v114
    v_add_f32 v119, v119, v120
    v_cos_f32 v116, v119
    v_sin_f32 v117, v119
    s_waitcnt vmcnt(12) lgkmcnt(0)
    v_mfma_f32_32x32x16_bf16 v[128:143], v[104:107], a[60:63], v[128:143]
    s_waitcnt vmcnt(11)
    v_cmp_ne_u32 vcc, s37, v126
    s_nop 1
    s_cbranch_vccnz L_s4_spin
L_s4_ok:
    s_barrier
    ds_read_b64_tr_b16 v[96:97], v18 offset:16384
    ds_read_b64_tr_b16 v[98:99], v18 offset:16896
    ds_read_b64_tr_b16 v[100:101], v19 offset:16384
    ds_read_b64_tr_b16 v[102:103], v19 offset:16896
    v_mfma_f32_32x32x16_bf16 v[144:159], v[108:111], a[60:63], v[144:159]
    buffer_load_dwordx4 a[44:47], v10, s[32:35], s46 offen offset:3072 sc1
    v_add_f32 v119, v119, v118
    v_cvt_pk_bf16_f32 v224, v116, v117
    v_alignbit_b32 v115, v224, v224, v121
    v_xor_b32 v72, v115, v114
    v_cos_f32 v116, v119
    s_waitcnt vmcnt(11) lgkmcnt(0)
    v_mfma_f32_32x32x16_bf16 v[128:143], v[96:99], a[0:3], v[128:143]
    ds_read_b64_tr_b16 v[104:105], v18 offset:18432
    ds_read_b64_tr_b16 v[106:107], v18 offset:18944
    ds_read_b64_tr_b16 v[108:109], v19 offset:18432
    ds_read_b64_tr_b16 v[110:111], v19 offset:18944
    v_mfma_f32_32x32x16_bf16 v[144:159], v[100:103], a[0:3], v[144:159]
    s_add_u32 s46, s56, 45056
    buffer_load_dwordx4 a[48:51], v10, s[32:35], s46 offen offset:0 sc1
    s_add_u32 m0, s41, 16384
    s_add_u32 s47, s59, 0
    buffer_load_dwordx4 v9, s[32:35], s47 offen sc1 lds
    v_sin_f32 v117, v119
    v_add_f32 v119, v119, v118
    v_cvt_pk_bf16_f32 v225, v116, v117
    v_alignbit_b32 v115, v225, v225, v121
    v_xor_b32 v73, v115, v114
    s_waitcnt vmcnt(12) lgkmcnt(0)
    v_mfma_f32_32x32x16_bf16 v[128:143], v[104:107], a[4:7], v[128:143]
    ds_read_b64_tr_b16 v[96:97], v18 offset:20480
    ds_read_b64_tr_b16 v[98:99], v18 offset:20992
    ds_read_b64_tr_b16 v[100:101], v19 offset:20480
    ds_read_b64_tr_b16 v[102:103], v19 offset:20992
    v_mfma_f32_32x32x16_bf16 v[144:159], v[108:111], a[4:7], v[144:159]
    buffer_load_dwordx4 a[52:55], v10, s[32:35], s46 offen offset:1024 sc1
    s_add_u32 m0, s41, 17408
    s_add_u32 s47, s59, 33792
    buffer_load_dwordx4 v9, s[32:35], s47 offen sc1 lds
    v_cos_f32 v116, v119
    v_sin_f32 v117, v119
    v_add_f32 v119, v119, v118
    v_cvt_pk_bf16_f32 v226, v116, v117
    v_alignbit_b32 v115, v226, v226, v121
    s_waitcnt vmcnt(13) lgkmcnt(0)
    v_mfma_f32_32x32x16_bf16 v[128:143], v[96:99], a[8:11], v[128:143]
    ds_read_b64_tr_b16 v[104:105], v18 offset:22528
    ds_read_b64_tr_b16 v[106:107], v18 offset:23040
    ds_read_b64_tr_b16 v[108:109], v19 offset:22528
    ds_read_b64_tr_b16 v[110:111], v19 offset:23040
    v_mfma_f32_32x32x16_bf16 v[144:159], v[100:103], a[8:11], v[144:159]
    buffer_load_dwordx4 a[56:59], v10, s[32:35], s46 offen offset:2048 sc1
    s_add_u32 m0, s41, 18432
    s_add_u32 s47, s59, 67584
    buffer_load_dwordx4 v9, s[32:35], s47 offen sc1 lds
    v_xor_b32 v74, v115, v114
    v_cos_f32 v116, v119
    v_sin_f32 v117, v119
    v_add_f32 v119, v119, v118
    v_cvt_pk_bf16_f32 v227, v116, v117
    s_waitcnt vmcnt(14) lgkmcnt(0)
    v_mfma_f32_32x32x16_bf16 v[128:143], v[104:107], a[12:15], v[128:143]
    s_waitcnt vmcnt(47)
    s_barrier
    ds_read_b64_tr_b16 v[96:97], v20 offset:16384
    ds_read_b64_tr_b16 v[98:99], v20 offset:16896
    ds_read_b64_tr_b16 v[100:101], v21 offset:16384
    ds_read_b64_tr_b16 v[102:103], v21 offset:16896
    v_mfma_f32_32x32x16_bf16 v[144:159], v[108:111], a[12:15], v[144:159]
    buffer_load_dwordx4 a[60:63], v10, s[32:35], s46 offen offset:3072 sc1
    s_add_u32 m0, s41, 19456
    s_add_u32 s47, s59, 101376
    buffer_load_dwordx4 v9, s[32:35], s47 offen sc1 lds
    v_alignbit_b32 v115, v227, v227, v121
    v_xor_b32 v75, v115, v114
    v_add_f32 v119, v119, v120
    v_cos_f32 v116, v119
    v_sin_f32 v117, v119
    s_waitcnt vmcnt(15) lgkmcnt(0)
    v_mfma_f32_32x32x16_bf16 v[128:143], v[96:99], a[16:19], v[128:143]
    ds_read_b64_tr_b16 v[104:105], v20 offset:18432
    ds_read_b64_tr_b16 v[106:107], v20 offset:18944
    ds_read_b64_tr_b16 v[108:109], v21 offset:18432
    ds_read_b64_tr_b16 v[110:111], v21 offset:18944
    v_mfma_f32_32x32x16_bf16 v[144:159], v[100:103], a[16:19], v[144:159]
    s_add_u32 s46, s56, 49152
    buffer_load_dwordx4 a[0:3], v10, s[32:35], s46 offen offset:0 sc1
    s_add_u32 m0, s41, 32768
    s_add_u32 s47, s59, 540672
    buffer_load_dwordx4 v9, s[32:35], s47 offen sc1 lds
    v_add_f32 v119, v119, v118
    v_cvt_pk_bf16_f32 v228, v116, v117
    v_alignbit_b32 v115, v228, v228, v121
    v_xor_b32 v76, v115, v114
    v_cos_f32 v116, v119
    s_waitcnt vmcnt(16) lgkmcnt(0)
    v_mfma_f32_32x32x16_bf16 v[128:143], v[104:107], a[20:23], v[128:143]
    ds_read_b64_tr_b16 v[96:97], v20 offset:20480
    ds_read_b64_tr_b16 v[98:99], v20 offset:20992
    ds_read_b64_tr_b16 v[100:101], v21 offset:20480
    ds_read_b64_tr_b16 v[102:103], v21 offset:20992
    v_mfma_f32_32x32x16_bf16 v[144:159], v[108:111], a[20:23], v[144:159]
    buffer_load_dwordx4 a[4:7], v10, s[32:35], s46 offen offset:1024 sc1
    s_add_u32 m0, s41, 33792
    s_add_u32 s47, s59, 574464
    buffer_load_dwordx4 v9, s[32:35], s47 offen sc1 lds
    v_sin_f32 v117, v119
    v_add_f32 v119, v119, v118
    v_cvt_pk_bf16_f32 v229, v116, v117
    v_alignbit_b32 v115, v229, v229, v121
    v_xor_b32 v77, v115, v114
    s_waitcnt vmcnt(17) lgkmcnt(0)
    v_mfma_f32_32x32x16_bf16 v[128:143], v[96:99], a[24:27], v[128:143]
    ds_read_b64_tr_b16 v[104:105], v20 offset:22528
    ds_read_b64_tr_b16 v[106:107], v20 offset:23040
    ds_read_b64_tr_b16 v[108:109], v21 offset:22528
    ds_read_b64_tr_b16 v[110:111], v21 offset:23040
    v_mfma_f32_32x32x16_bf16 v[144:159], v[100:103], a[24:27], v[144:159]
    buffer_load_dwordx4 a[8:11], v10, s[32:35], s46 offen offset:2048 sc1
    s_add_u32 m0, s41, 34816
    s_add_u32 s47, s59, 608256
    buffer_load_dwordx4 v9, s[32:35], s47 offen sc1 lds
    v_cos_f32 v116, v119
    v_sin_f32 v117, v119
    v_add_f32 v119, v119, v118
    v_cvt_pk_bf16_f32 v230, v116, v117
    v_alignbit_b32 v115, v230, v230, v121
    s_waitcnt vmcnt(18) lgkmcnt(0)
    v_mfma_f32_32x32x16_bf16 v[128:143], v[104:107], a[28:31], v[128:143]
    s_waitcnt vmcnt(47)
    s_barrier
    ds_read_b64_tr_b16 v[96:97], v18 offset:32768
    ds_read_b64_tr_b16 v[98:99], v18 offset:33280
    ds_read_b64_tr_b16 v[100:101], v19 offset:32768
    ds_read_b64_tr_b16 v[102:103], v19 offset:33280
    v_mfma_f32_32x32x16_bf16 v[144:159], v[108:111], a[28:31], v[144:159]
    buffer_load_dwordx4 a[12:15], v10, s[32:35], s46 offen offset:3072 sc1
    s_add_u32 m0, s41, 35840
    s_add_u32 s47, s59, 642048
    buffer_load_dwordx4 v9, s[32:35], s47 offen sc1 lds
    v_xor_b32 v78, v115, v114
    v_cos_f32 v116, v119
    v_sin_f32 v117, v119
    v_add_f32 v119, v119, v118
    v_cvt_pk_bf16_f32 v231, v116, v117
    s_lshl_b32 m0, s36, 11
    s_add_u32 m0, m0, 81920
    s_nop 0
    buffer_load_dwordx4 v12, s[4:7], s38 offen lds
    s_add_u32 m0, m0, 1024
    s_add_u32 s47, s38, 32768
    buffer_load_dwordx4 v7, s[4:7], s47 offen lds
    s_waitcnt vmcnt(21) lgkmcnt(0)
    v_mfma_f32_32x32x16_bf16 v[128:143], v[96:99], a[32:35], v[128:143]
    ds_read_b64_tr_b16 v[104:105], v18 offset:34816
    ds_read_b64_tr_b16 v[106:107], v18 offset:35328
    ds_read_b64_tr_b16 v[108:109], v19 offset:34816
    ds_read_b64_tr_b16 v[110:111], v19 offset:35328
    v_mfma_f32_32x32x16_bf16 v[144:159], v[100:103], a[32:35], v[144:159]
    s_add_u32 s46, s56, 53248
    buffer_load_dwordx4 a[16:19], v10, s[32:35], s46 offen offset:0 sc1
    s_add_u32 m0, s41, 49152
    s_add_u32 s47, s59, 1081344
    buffer_load_dwordx4 v9, s[32:35], s47 offen sc1 lds
    v_alignbit_b32 v115, v231, v231, v121
    v_xor_b32 v79, v115, v114
    v_add_f32 v119, v119, v120
    v_cos_f32 v116, v119
    v_sin_f32 v117, v119
    s_waitcnt vmcnt(22) lgkmcnt(0)
    v_mfma_f32_32x32x16_bf16 v[128:143], v[104:107], a[36:39], v[128:143]
    ds_read_b64_tr_b16 v[96:97], v18 offset:36864
    ds_read_b64_tr_b16 v[98:99], v18 offset:37376
    ds_read_b64_tr_b16 v[100:101], v19 offset:36864
    ds_read_b64_tr_b16 v[102:103], v19 offset:37376
    v_mfma_f32_32x32x16_bf16 v[144:159], v[108:111], a[36:39], v[144:159]
    buffer_load_dwordx4 a[20:23], v10, s[32:35], s46 offen offset:1024 sc1
    s_add_u32 m0, s41, 50176
    s_add_u32 s47, s59, 1115136
    buffer_load_dwordx4 v9, s[32:35], s47 offen sc1 lds
    v_add_f32 v119, v119, v118
    v_cvt_pk_bf16_f32 v232, v116, v117
    v_alignbit_b32 v115, v232, v232, v121
    v_xor_b32 v80, v115, v114
    v_cos_f32 v116, v119
    s_waitcnt vmcnt(23) lgkmcnt(0)
    v_mfma_f32_32x32x16_bf16 v[128:143], v[96:99], a[40:43], v[128:143]
    ds_read_b64_tr_b16 v[104:105], v18 offset:38912
    ds_read_b64_tr_b16 v[106:107], v18 offset:39424
    ds_read_b64_tr_b16 v[108:109], v19 offset:38912
    ds_read_b64_tr_b16 v[110:111], v19 offset:39424
    v_mfma_f32_32x32x16_bf16 v[144:159], v[100:103], a[40:43], v[144:159]
    buffer_load_dwordx4 a[24:27], v10, s[32:35], s46 offen offset:2048 sc1
    s_add_u32 m0, s41, 51200
    s_add_u32 s47, s59, 1148928
    buffer_load_dwordx4 v9, s[32:35], s47 offen sc1 lds
    v_sin_f32 v117, v119
    v_add_f32 v119, v119, v118
    v_cvt_pk_bf16_f32 v233, v116, v117
    v_alignbit_b32 v115, v233, v233, v121
    v_xor_b32 v81, v115, v114
    s_waitcnt vmcnt(24) lgkmcnt(0)
    v_mfma_f32_32x32x16_bf16 v[128:143], v[104:107], a[44:47], v[128:143]
    s_waitcnt vmcnt(49)
    s_barrier
    ds_read_b64_tr_b16 v[96:97], v18 offset:49152
    ds_read_b64_tr_b16 v[98:99], v18 offset:49664
    ds_read_b64_tr_b16 v[100:101], v19 offset:49152
    ds_read_b64_tr_b16 v[102:103], v19 offset:49664
    v_mfma_f32_32x32x16_bf16 v[144:159], v[108:111], a[44:47], v[144:159]
    buffer_load_dwordx4 a[28:31], v10, s[32:35], s46 offen offset:3072 sc1
    s_add_u32 m0, s41, 52224
    s_add_u32 s47, s59, 1182720
    buffer_load_dwordx4 v9, s[32:35], s47 offen sc1 lds
    v_cos_f32 v116, v119
    v_sin_f32 v117, v119
    v_add_f32 v119, v119, v118
    v_cvt_pk_bf16_f32 v234, v116, v117
    v_alignbit_b32 v115, v234, v234, v121
    s_waitcnt vmcnt(25) lgkmcnt(0)
    v_mfma_f32_32x32x16_bf16 v[128:143], v[96:99], a[48:51], v[128:143]
    ds_read_b64_tr_b16 v[104:105], v18 offset:51200
    ds_read_b64_tr_b16 v[106:107], v18 offset:51712
    ds_read_b64_tr_b16 v[108:109], v19 offset:51200
    ds_read_b64_tr_b16 v[110:111], v19 offset:51712
    v_mfma_f32_32x32x16_bf16 v[144:159], v[100:103], a[48:51], v[144:159]
    s_add_u32 m0, s41, 65536
    s_add_u32 s47, s59, 1622016
    buffer_load_dwordx4 v9, s[32:35], s47 offen sc1 lds
    v_xor_b32 v82, v115, v114
    v_cos_f32 v116, v119
    v_sin_f32 v117, v119
    v_add_f32 v119, v119, v118
    v_cvt_pk_bf16_f32 v235, v116, v117
    s_waitcnt vmcnt(24) lgkmcnt(0)
    v_mfma_f32_32x32x16_bf16 v[128:143], v[104:107], a[52:55], v[128:143]
    ds_read_b64_tr_b16 v[96:97], v18 offset:53248
    ds_read_b64_tr_b16 v[98:99], v18 offset:53760
    ds_read_b64_tr_b16 v[100:101], v19 offset:53248
    ds_read_b64_tr_b16 v[102:103], v19 offset:53760
    v_mfma_f32_32x32x16_bf16 v[144:159], v[108:111], a[52:55], v[144:159]
    s_add_u32 m0, s41, 66560
    s_add_u32 s47, s59, 1655808
    buffer_load_dwordx4 v9, s[32:35], s47 offen sc1 lds
    v_alignbit_b32 v115, v235, v235, v121
    v_xor_b32 v83, v115, v114
    v_add_f32 v119, v119, v120
    v_cos_f32 v116, v119
    v_sin_f32 v117, v119
    s_waitcnt vmcnt(23) lgkmcnt(0)
    v_mfma_f32_32x32x16_bf16 v[128:143], v[96:99], a[56:59], v[128:143]
    ds_read_b64_tr_b16 v[104:105], v18 offset:55296
    ds_read_b64_tr_b16 v[106:107], v18 offset:55808
    ds_read_b64_tr_b16 v[108:109], v19 offset:55296
    ds_read_b64_tr_b16 v[110:111], v19 offset:55808
    v_mfma_f32_32x32x16_bf16 v[144:159], v[100:103], a[56:59], v[144:159]
    s_add_u32 m0, s41, 67584
    s_add_u32 s47, s59, 1689600
    buffer_load_dwordx4 v9, s[32:35], s47 offen sc1 lds
    v_add_f32 v119, v119, v118
    v_cvt_pk_bf16_f32 v236, v116, v117
    v_alignbit_b32 v115, v236, v236, v121
    v_xor_b32 v84, v115, v114
    v_cos_f32 v116, v119
    s_waitcnt vmcnt(22) lgkmcnt(0)
    v_mfma_f32_32x32x16_bf16 v[128:143], v[104:107], a[60:63], v[128:143]
    s_waitcnt vmcnt(46)
    s_barrier
    ds_read_b64_tr_b16 v[96:97], v20 offset:0
    ds_read_b64_tr_b16 v[98:99], v20 offset:512
    ds_read_b64_tr_b16 v[100:101], v21 offset:0
    ds_read_b64_tr_b16 v[102:103], v21 offset:512
    v_mfma_f32_32x32x16_bf16 v[144:159], v[108:111], a[60:63], v[144:159]
    s_add_u32 m0, s41, 68608
    s_add_u32 s47, s59, 1723392
    buffer_load_dwordx4 v9, s[32:35], s47 offen sc1 lds
    v_sin_f32 v117, v119
    v_add_f32 v119, v119, v118
    v_cvt_pk_bf16_f32 v237, v116, v117
    v_alignbit_b32 v115, v237, v237, v121
    v_xor_b32 v85, v115, v114
    s_waitcnt vmcnt(21) lgkmcnt(0)
    v_mfma_f32_32x32x16_bf16 v[128:143], v[96:99], a[0:3], v[128:143]
    ds_read_b64_tr_b16 v[104:105], v20 offset:2048
    ds_read_b64_tr_b16 v[106:107], v20 offset:2560
    ds_read_b64_tr_b16 v[108:109], v21 offset:2048
    ds_read_b64_tr_b16 v[110:111], v21 offset:2560
    v_mfma_f32_32x32x16_bf16 v[144:159], v[100:103], a[0:3], v[144:159]
    v_cos_f32 v116, v119
    v_sin_f32 v117, v119
    v_add_f32 v119, v119, v118
    v_cvt_pk_bf16_f32 v238, v116, v117
    v_alignbit_b32 v115, v238, v238, v121
    s_waitcnt vmcnt(19) lgkmcnt(0)
    v_mfma_f32_32x32x16_bf16 v[128:143], v[104:107], a[4:7], v[128:143]
    ds_read_b64_tr_b16 v[96:97], v20 offset:4096
    ds_read_b64_tr_b16 v[98:99], v20 offset:4608
    ds_read_b64_tr_b16 v[100:101], v21 offset:4096
    ds_read_b64_tr_b16 v[102:103], v21 offset:4608
    v_mfma_f32_32x32x16_bf16 v[144:159], v[108:111], a[4:7], v[144:159]
    v_xor_b32 v86, v115, v114
    v_cos_f32 v116, v119
    v_sin_f32 v117, v119
    v_add_f32 v119, v119, v118
    v_cvt_pk_bf16_f32 v239, v116, v117
    s_waitcnt vmcnt(17) lgkmcnt(0)
    v_mfma_f32_32x32x16_bf16 v[128:143], v[96:99], a[8:11], v[128:143]
    ds_read_b64_tr_b16 v[104:105], v20 offset:6144
    ds_read_b64_tr_b16 v[106:107], v20 offset:6656
    ds_read_b64_tr_b16 v[108:109], v21 offset:6144
    ds_read_b64_tr_b16 v[110:111], v21 offset:6656
    v_mfma_f32_32x32x16_bf16 v[144:159], v[100:103], a[8:11], v[144:159]
    v_alignbit_b32 v115, v239, v239, v121
    v_xor_b32 v87, v115, v114
    v_cmp_lt_u32 vcc, 31, v1
    v_and_b32 v116, 0x8000, v87
    v_or_b32 v116, 0x3f00, v116
    s_waitcnt vmcnt(15) lgkmcnt(0)
    v_mfma_f32_32x32x16_bf16 v[128:143], v[104:107], a[12:15], v[128:143]
    s_waitcnt vmcnt(22)
    s_barrier
    v_mfma_f32_32x32x16_bf16 v[144:159], v[108:111], a[12:15], v[144:159]
    v_cndmask_b32 v87, v87, v116, vcc
    s_waitcnt vmcnt(11) lgkmcnt(0)
    v_mfma_f32_32x32x16_bf16 v[128:143], a[136:139], a[16:19], v[128:143]
    v_mfma_f32_32x32x16_bf16 v[144:159], a[140:143], a[16:19], v[144:159]
    s_waitcnt vmcnt(9) lgkmcnt(0)
    v_mfma_f32_32x32x16_bf16 v[128:143], a[144:147], a[20:23], v[128:143]
    v_mfma_f32_32x32x16_bf16 v[144:159], a[148:151], a[20:23], v[144:159]
    s_waitcnt vmcnt(7) lgkmcnt(0)
    v_mfma_f32_32x32x16_bf16 v[128:143], a[152:155], a[24:27], v[128:143]
    v_mfma_f32_32x32x16_bf16 v[144:159], a[156:159], a[24:27], v[144:159]
    s_waitcnt vmcnt(5) lgkmcnt(0)
    v_mfma_f32_32x32x16_bf16 v[128:143], a[160:163], a[28:31], v[128:143]
    ds_read_b64_tr_b16 a[200:201], v8 offset:0
    ds_read_b64_tr_b16 a[202:203], v8 offset:512
    ds_read_b64_tr_b16 a[204:205], v8 offset:2048
    ds_read_b64_tr_b16 a[206:207], v8 offset:2560
    ds_read_b64_tr_b16 a[208:209], v8 offset:4096
    ds_read_b64_tr_b16 a[210:211], v8 offset:4608
    v_mfma_f32_32x32x16_bf16 v[144:159], a[164:167], a[28:31], v[144:159]
    v_mov_b32 v120, 0xbfb8aa3b
    v_mov_b32 v121, 0x49000000
    v_xor_b32 v114, 0x1000, v13
    v_xor_b32 v115, 16, v14
    s_lshl_b32 s46, s36, 11
    s_add_u32 s46, s46, 81920
    v_add_u32 v118, s46, v10
    s_add_u32 s47, s38, 32768
    s_waitcnt lgkmcnt(4)
    v_mfma_f32_32x32x16_bf16 v[160:175], v[176:179], a[200:203], 0
    ds_read_b64_tr_b16 a[212:213], v8 offset:6144
    ds_read_b64_tr_b16 a[214:215], v8 offset:6656
    s_waitcnt lgkmcnt(4)
    v_mfma_f32_32x32x16_bf16 v[160:175], v[180:183], a[204:207], v[160:175]
    ds_write_b128 v13, v[144:147] offset:0
    ds_write_b128 v13, v[148:151] offset:1024
    ds_write_b128 v13, v[152:155] offset:2048
    ds_write_b128 v13, v[156:159] offset:3072
    ds_read_b64_tr_b16 a[200:201], v8 offset:8192
    ds_read_b64_tr_b16 a[202:203], v8 offset:8704
    s_waitcnt lgkmcnt(8)
    v_mfma_f32_32x32x16_bf16 v[160:175], v[184:187], a[208:211], v[160:175]
    ds_read_b64_tr_b16 a[204:205], v8 offset:10240
    ds_read_b64_tr_b16 a[206:207], v8 offset:10752
    s_waitcnt lgkmcnt(8)
    v_mfma_f32_32x32x16_bf16 v[160:175], v[188:191], a[212:215], v[160:175]
    s_waitcnt vmcnt(12)
    s_waitcnt lgkmcnt(4)
    s_barrier
    ds_read_b64_tr_b16 a[208:209], v8 offset:12288
    ds_read_b64_tr_b16 a[210:211], v8 offset:12800
    ds_read_b128 v[16:19], v14
    ds_read_b128 v[20:23], v115
    ds_read_b128 v[144:147], v114 offset:0
    ds_read_b128 v[148:151], v114 offset:1024
    ds_read_b128 v[152:155], v114 offset:2048
    ds_read_b128 v[156:159], v114 offset:3072
    s_waitcnt lgkmcnt(10)
    v_mfma_f32_32x32x16_bf16 v[160:175], v[192:195], a[200:203], v[160:175]
    ds_read_b64_tr_b16 a[212:213], v8 offset:14336
    ds_read_b64_tr_b16 a[214:215], v8 offset:14848
    s_waitcnt lgkmcnt(10)
    v_mfma_f32_32x32x16_bf16 v[160:175], v[196:199], a[204:207], v[160:175]
    ds_read_b64_tr_b16 a[200:201], v8 offset:16384
    ds_read_b64_tr_b16 a[202:203], v8 offset:16896
    s_waitcnt lgkmcnt(10)
    v_mfma_f32_32x32x16_bf16 v[160:175], v[200:203], a[208:211], v[160:175]
    ds_read_b64_tr_b16 a[204:205], v8 offset:18432
    ds_read_b64_tr_b16 a[206:207], v8 offset:18944
    s_waitcnt lgkmcnt(6)
    v_lshlrev_b32 v96, 16, v16
    v_and_b32 v97, 0xffff0000, v16
    v_lshlrev_b32 v98, 16, v17
    v_and_b32 v99, 0xffff0000, v17
    s_waitcnt lgkmcnt(4)
    v_mfma_f32_32x32x16_bf16 v[160:175], v[204:207], a[212:215], v[160:175]
    ds_read_b64_tr_b16 a[208:209], v8 offset:20480
    ds_read_b64_tr_b16 a[210:211], v8 offset:20992
    v_lshlrev_b32 v100, 16, v18
    v_and_b32 v101, 0xffff0000, v18
    v_lshlrev_b32 v102, 16, v19
    v_and_b32 v103, 0xffff0000, v19
    s_waitcnt lgkmcnt(4)
    v_mfma_f32_32x32x16_bf16 v[160:175], v[208:211], a[200:203], v[160:175]
    ds_read_b64_tr_b16 a[212:213], v8 offset:22528
    ds_read_b64_tr_b16 a[214:215], v8 offset:23040
    v_lshlrev_b32 v104, 16, v20
    v_and_b32 v105, 0xffff0000, v20
    v_lshlrev_b32 v106, 16, v21
    v_and_b32 v107, 0xffff0000, v21
    s_waitcnt lgkmcnt(4)
    v_mfma_f32_32x32x16_bf16 v[160:175], v[212:215], a[204:207], v[160:175]
    ds_read_b64_tr_b16 a[200:201], v8 offset:24576
    ds_read_b64_tr_b16 a[202:203], v8 offset:25088
    v_lshlrev_b32 v108, 16, v22
    v_and_b32 v109, 0xffff0000, v22
    v_lshlrev_b32 v110, 16, v23
    v_and_b32 v111, 0xffff0000, v23
    s_waitcnt lgkmcnt(4)
    v_mfma_f32_32x32x16_bf16 v[160:175], v[216:219], a[208:211], v[160:175]
    ds_read_b64_tr_b16 a[204:205], v8 offset:26624
    ds_read_b64_tr_b16 a[206:207], v8 offset:27136
    v_add_f32 v128, v128, v144
    v_add_f32 v129, v129, v145
    v_add_f32 v130, v130, v146
    v_add_f32 v131, v131, v147
    s_waitcnt lgkmcnt(4)
    v_mfma_f32_32x32x16_bf16 v[160:175], v[220:223], a[212:215], v[160:175]
    ds_read_b64_tr_b16 a[208:209], v8 offset:28672
    ds_read_b64_tr_b16 a[210:211], v8 offset:29184
    v_add_f32 v132, v132, v148
    v_add_f32 v133, v133, v149
    v_add_f32 v134, v134, v150
    v_add_f32 v135, v135, v151
    s_waitcnt lgkmcnt(4)
    v_mfma_f32_32x32x16_bf16 v[160:175], v[224:227], a[200:203], v[160:175]
    s_waitcnt vmcnt(4)
    s_barrier
    ds_read_b64_tr_b16 a[212:213], v8 offset:30720
    ds_read_b64_tr_b16 a[214:215], v8 offset:31232
    v_add_f32 v136, v136, v152
    v_add_f32 v137, v137, v153
    v_add_f32 v138, v138, v154
    v_add_f32 v139, v139, v155
    s_waitcnt lgkmcnt(4)
    v_mfma_f32_32x32x16_bf16 v[160:175], v[228:231], a[204:207], v[160:175]
    ds_read_b64_tr_b16 a[200:201], v8 offset:32768
    ds_read_b64_tr_b16 a[202:203], v8 offset:33280
    v_add_f32 v140, v140, v156
    v_add_f32 v141, v141, v157
    v_mul_f32 v240, v120, v128
    v_mul_f32 v241, v120, v129
    s_waitcnt lgkmcnt(4)
    v_mfma_f32_32x32x16_bf16 v[160:175], v[232:235], a[208:211], v[160:175]
    ds_read_b64_tr_b16 a[204:205], v8 offset:34816
    ds_read_b64_tr_b16 a[206:207], v8 offset:35328
    v_mul_f32 v242, v120, v130
    v_mul_f32 v243, v120, v131
    v_mul_f32 v244, v120, v132
    v_mul_f32 v245, v120, v133
    s_waitcnt lgkmcnt(4)
    v_mfma_f32_32x32x16_bf16 v[160:175], v[236:239], a[212:215], v[160:175]
    ds_read_b64_tr_b16 a[208:209], v8 offset:36864
    ds_read_b64_tr_b16 a[210:211], v8 offset:37376
    v_mul_f32 v246, v120, v134
    v_mul_f32 v247, v120, v135
    v_mul_f32 v248, v120, v136
    v_mul_f32 v249, v120, v137
    s_waitcnt lgkmcnt(4)
    v_mfma_f32_32x32x16_bf16 v[160:175], v[24:27], a[200:203], v[160:175]
    ds_read_b64_tr_b16 a[212:213], v8 offset:38912
    ds_read_b64_tr_b16 a[214:215], v8 offset:39424
    v_mul_f32 v250, v120, v138
    v_mul_f32 v251, v120, v139
    v_mul_f32 v252, v120, v140
    v_mul_f32 v253, v120, v141
    s_waitcnt lgkmcnt(4)
    v_mfma_f32_32x32x16_bf16 v[160:175], v[28:31], a[204:207], v[160:175]
    ds_read_b64_tr_b16 a[200:201], v8 offset:40960
    ds_read_b64_tr_b16 a[202:203], v8 offset:41472
    v_exp_f32 v240, v240
    v_exp_f32 v241, v241
    v_exp_f32 v242, v242
    v_exp_f32 v243, v243
    s_waitcnt lgkmcnt(4)
    v_mfma_f32_32x32x16_bf16 v[160:175], v[32:35], a[208:211], v[160:175]
    ds_read_b64_tr_b16 a[204:205], v8 offset:43008
    ds_read_b64_tr_b16 a[206:207], v8 offset:43520
    v_exp_f32 v244, v244
    v_exp_f32 v245, v245
    v_exp_f32 v246, v246
    v_exp_f32 v247, v247
    s_waitcnt lgkmcnt(4)
    v_mfma_f32_32x32x16_bf16 v[160:175], v[36:39], a[212:215], v[160:175]
    ds_read_b64_tr_b16 a[208:209], v8 offset:45056
    ds_read_b64_tr_b16 a[210:211], v8 offset:45568
    v_exp_f32 v248, v248
    v_exp_f32 v249, v249
    v_exp_f32 v250, v250
    v_exp_f32 v251, v251
    s_waitcnt lgkmcnt(4)
    v_mfma_f32_32x32x16_bf16 v[160:175], v[40:43], a[200:203], v[160:175]
    s_waitcnt vmcnt(0)
    s_barrier
    ds_read_b64_tr_b16 a[212:213], v8 offset:47104
    ds_read_b64_tr_b16 a[214:215], v8 offset:47616
    v_exp_f32 v252, v252
    v_exp_f32 v253, v253
    v_fma_f32 v240, v240, v121, v121
    v_fma_f32 v241, v241, v121, v121
    s_waitcnt lgkmcnt(4)
    v_mfma_f32_32x32x16_bf16 v[160:175], v[44:47], a[204:207], v[160:175]
    ds_read_b64_tr_b16 a[200:201], v8 offset:49152
    ds_read_b64_tr_b16 a[202:203], v8 offset:49664
    v_fma_f32 v242, v242, v121, v121
    v_fma_f32 v243, v243, v121, v121
    v_fma_f32 v244, v244, v121, v121
    v_fma_f32 v245, v245, v121, v121
    s_waitcnt lgkmcnt(4)
    v_mfma_f32_32x32x16_bf16 v[160:175], v[48:51], a[208:211], v[160:175]
    ds_read_b64_tr_b16 a[204:205], v8 offset:51200
    ds_read_b64_tr_b16 a[206:207], v8 offset:51712
    v_fma_f32 v246, v246, v121, v121
    v_fma_f32 v247, v247, v121, v121
    v_fma_f32 v248, v248, v121, v121
    v_fma_f32 v249, v249, v121, v121
    s_waitcnt lgkmcnt(4)
    v_mfma_f32_32x32x16_bf16 v[160:175], v[52:55], a[212:215], v[160:175]
    ds_read_b64_tr_b16 a[208:209], v8 offset:53248
    ds_read_b64_tr_b16 a[210:211], v8 offset:53760
    v_fma_f32 v250, v250, v121, v121
    v_fma_f32 v251, v251, v121, v121
    v_fma_f32 v252, v252, v121, v121
    v_fma_f32 v253, v253, v121, v121
    s_waitcnt lgkmcnt(4)
    v_mfma_f32_32x32x16_bf16 v[160:175], v[56:59], a[200:203], v[160:175]
    ds_read_b64_tr_b16 a[212:213], v8 offset:55296
    ds_read_b64_tr_b16 a[214:215], v8 offset:55808
    v_rcp_f32 v240, v240
    v_rcp_f32 v241, v241
    v_rcp_f32 v242, v242
    v_rcp_f32 v243, v243
    s_waitcnt lgkmcnt(4)
    v_mfma_f32_32x32x16_bf16 v[160:175], v[60:63], a[204:207], v[160:175]
    ds_read_b64_tr_b16 a[200:201], v8 offset:57344
    ds_read_b64_tr_b16 a[202:203], v8 offset:57856
    v_rcp_f32 v244, v244
    v_rcp_f32 v245, v245
    v_rcp_f32 v246, v246
    v_rcp_f32 v247, v247
    s_waitcnt lgkmcnt(4)
    v_mfma_f32_32x32x16_bf16 v[160:175], v[64:67], a[208:211], v[160:175]
    ds_read_b64_tr_b16 a[204:205], v8 offset:59392
    ds_read_b64_tr_b16 a[206:207], v8 offset:59904
    v_rcp_f32 v248, v248
    v_rcp_f32 v249, v249
    v_rcp_f32 v250, v250
    v_rcp_f32 v251, v251
    s_waitcnt lgkmcnt(4)
    v_mfma_f32_32x32x16_bf16 v[160:175], v[68:71], a[212:215], v[160:175]
    ds_read_b64_tr_b16 a[208:209], v8 offset:61440
    ds_read_b64_tr_b16 a[210:211], v8 offset:61952
    v_rcp_f32 v252, v252
    v_rcp_f32 v253, v253
    v_mul_f32 v240, v240, v128
    v_mul_f32 v241, v241, v129
    s_waitcnt lgkmcnt(4)
    v_mfma_f32_32x32x16_bf16 v[160:175], v[72:75], a[200:203], v[160:175]
    ds_read_b64_tr_b16 a[212:213], v8 offset:63488
    ds_read_b64_tr_b16 a[214:215], v8 offset:64000
    v_mul_f32 v242, v242, v130
    v_mul_f32 v243, v243, v131
    v_mul_f32 v244, v244, v132
    v_mul_f32 v245, v245, v133
    s_waitcnt lgkmcnt(4)
    v_mfma_f32_32x32x16_bf16 v[160:175], v[76:79], a[204:207], v[160:175]
    v_mul_f32 v246, v246, v134
    v_mul_f32 v247, v247, v135
    v_mul_f32 v248, v248, v136
    v_mul_f32 v249, v249, v137
    s_waitcnt lgkmcnt(2)
    v_mfma_f32_32x32x16_bf16 v[160:175], v[80:83], a[208:211], v[160:175]
    v_mul_f32 v250, v250, v138
    v_mul_f32 v251, v251, v139
    v_mul_f32 v252, v252, v140
    v_mul_f32 v253, v253, v141
    s_waitcnt lgkmcnt(0)
    v_mfma_f32_32x32x16_bf16 v[160:175], v[84:87], a[212:215], v[160:175]
    v_pk_add_f32 v[142:143], v[142:143], v[158:159]
    v_pk_mul_f32 v[254:255], v[142:143], v[120:121] op_sel_hi:[1,0]
    v_exp_f32 v254, v254
    v_exp_f32 v255, v255
    s_nop 0
    v_pk_fma_f32 v[254:255], v[254:255], v[120:121], v[120:121] op_sel:[0,1,1] op_sel_hi:[1,1,1]
    v_rcp_f32 v254, v254
    v_rcp_f32 v255, v255
    s_nop 0
    v_pk_mul_f32 v[254:255], v[254:255], v[142:143]
    s_nop 1
    v_pk_fma_f32 v[96:97], v[160:161], v[240:241], v[96:97]
    v_pk_fma_f32 v[98:99], v[162:163], v[242:243], v[98:99]
    v_pk_fma_f32 v[100:101], v[164:165], v[244:245], v[100:101]
    v_pk_fma_f32 v[102:103], v[166:167], v[246:247], v[102:103]
    v_cvt_pk_bf16_f32 v16, v96, v97
    v_cvt_pk_bf16_f32 v17, v98, v99
    v_cvt_pk_bf16_f32 v18, v100, v101
    v_cvt_pk_bf16_f32 v19, v102, v103
    ds_write_b128 v14, v[16:19]
    v_pk_fma_f32 v[104:105], v[168:169], v[248:249], v[104:105]
    v_pk_fma_f32 v[106:107], v[170:171], v[250:251], v[106:107]
    v_pk_fma_f32 v[108:109], v[172:173], v[252:253], v[108:109]
    v_pk_fma_f32 v[110:111], v[174:175], v[254:255], v[110:111]
    v_cvt_pk_bf16_f32 v20, v104, v105
    v_cvt_pk_bf16_f32 v21, v106, v107
    v_cvt_pk_bf16_f32 v22, v108, v109
    v_cvt_pk_bf16_f32 v23, v110, v111
    ds_write_b128 v115, v[20:23]
    s_waitcnt lgkmcnt(0)
    s_barrier
    ds_read_b128 v[144:147], v118
    ds_read_b128 v[148:151], v118 offset:1024
    s_waitcnt lgkmcnt(1)
    buffer_store_dwordx4 v[144:147], v12, s[28:31], s38 offen sc1
    s_waitcnt lgkmcnt(0)
    buffer_store_dwordx4 v[148:151], v7, s[28:31], s47 offen sc1
L_end:
    s_endpgm
L_s1_spin:
    s_mov_b32 s100, 0
L_s1_again:
    s_sleep 4
    buffer_load_dword v126, v15, s[32:35], s51 offen sc1
    s_add_u32 s100, s100, 1
    s_cmp_gt_u32 s100, 100000
    s_cbranch_scc1 L_s1_ok
    s_waitcnt vmcnt(0)
    v_cmp_ne_u32 vcc, s37, v126
    s_nop 1
    s_cbranch_vccnz L_s1_again
    s_branch L_s1_ok
L_s2a_spin:
    s_mov_b32 s100, 0
L_s2a_again:
    buffer_load_dword v126, v15, s[32:35], s51 offen sc1
    s_add_u32 s100, s100, 1
    s_cmp_gt_u32 s100, 100000
    s_cbranch_scc1 L_s2a_ok
    s_waitcnt vmcnt(0)
    v_cmp_ne_u32 vcc, s37, v126
    s_nop 1
    s_cbranch_vccnz L_s2a_again
    s_branch L_s2a_ok
L_s2b_spin:
    s_mov_b32 s100, 0
L_s2b_again:
    s_sleep 16
    buffer_load_dword v126, v15, s[32:35], s51 offen sc1
    s_add_u32 s100, s100, 1
    s_cmp_gt_u32 s100, 100000
    s_cbranch_scc1 L_s2b_ok
    s_waitcnt vmcnt(0)
    v_cmp_ne_u32 vcc, s37, v126
    s_nop 1
    s_cbranch_vccnz L_s2b_again
    s_branch L_s2b_ok
L_s3_spin:
    s_mov_b32 s100, 0
L_s3_again:
    s_sleep 4
    buffer_load_dword v126, v15, s[32:35], s51 offen sc1
    s_add_u32 s100, s100, 1
    s_cmp_gt_u32 s100, 100000
    s_cbranch_scc1 L_s3_ok
    s_waitcnt vmcnt(0)
    v_cmp_ne_u32 vcc, s37, v126
    s_nop 1
    s_cbranch_vccnz L_s3_again
    s_branch L_s3_ok
L_s4_spin:
    s_mov_b32 s100, 0
L_s4_again:
    buffer_load_dword v126, v15, s[32:35], s51 offen sc1
    s_add_u32 s100, s100, 1
    s_cmp_gt_u32 s100, 100000
    s_cbranch_scc1 L_s4_ok
    s_waitcnt vmcnt(0)
    v_cmp_ne_u32 vcc, s37, v126
    s_nop 1
    s_cbranch_vccnz L_s4_again
    s_branch L_s4_ok
L_code_end:
.section .rodata,"a"
.p2align 6
.amdhsa_kernel recurrent_scan__spectral_gfnet__glu_gated_glu__prompt_kernel
  .amdhsa_next_free_vgpr 512
  .amdhsa_next_free_sgpr 102
  .amdhsa_accum_offset 256
  .amdhsa_group_segment_fixed_size 0
  .amdhsa_kernarg_size 80
  .amdhsa_user_sgpr_count 2
  .amdhsa_user_sgpr_kernarg_segment_ptr 1
  .amdhsa_system_sgpr_workgroup_id_x 1
.end_amdhsa_kernel
```
